```python
import torch

def _softmax(x, axis=-1):
    return torch.softmax(x, dim=axis)
def _gelu(x):
    return torch.nn.functional.gelu(x, approximate="tanh")
def _silu(x):
    return torch.nn.functional.silu(x)
def _sigmoid(x):
    return torch.sigmoid(x)
def _layernorm(x, axis=-1, eps=1e-5):
    m = x.mean(dim=axis, keepdim=True)
    v = x.var(dim=axis, keepdim=True, unbiased=False)
    return (x - m) / torch.sqrt(v + eps)
def _scatter_add(tgt, idx, src, axis=0):
    return tgt.clone().index_add_(axis, idx, src)
def _segment_sum(src, seg, n):
    out = torch.zeros((n,) + src.shape[1:], dtype=src.dtype)
    return out.index_add_(0, seg, src)
def _pad(x, pw):
    flat = tuple(v for pair in reversed(pw) for v in pair)
    return torch.nn.functional.pad(x, flat)

kernel_name = 'parallel_sum__ssm_conv_s5__glu_gated_geglu__prompt'

def setup_inputs():

    _w = (lambda a: (lambda t: t.to(torch.bfloat16) if t.is_floating_point() else t)(torch.as_tensor(a)))
    def _A_setup():
        B, S, D = 1, 2048, 512
        P = D
        Lambda_re = -0.5 * (lambda _x: torch.exp(torch.as_tensor(_x)))((lambda *s: torch.randn(*s, dtype=torch.bfloat16) * 0.2)(P))
        Lambda_im = (lambda *s: torch.randn(*s, dtype=torch.bfloat16) * 0.4)(P) * 1.0
        B_re = (lambda *s: torch.randn(*s, dtype=torch.bfloat16) * 0.2)(P, D) * (D ** -0.5)
        B_im = (lambda *s: torch.randn(*s, dtype=torch.bfloat16) * 0.2)(P, D) * (D ** -0.5)
        C_re = (lambda *s: torch.randn(*s, dtype=torch.bfloat16) * 0.2)(D, P) * (P ** -0.5)
        C_im = (lambda *s: torch.randn(*s, dtype=torch.bfloat16) * 0.2)(D, P) * (P ** -0.5)
        log_dt = (lambda *s: torch.randn(*s, dtype=torch.bfloat16) * 0.2)(P) * 0.3 - 2.0
        Dskip = (lambda *s: torch.randn(*s, dtype=torch.bfloat16) * 0.05)(D)
        return {
            "x": _w((lambda *s: torch.randn(*s, dtype=torch.bfloat16) * 0.05)(B, S, D)),
            "Lambda_re": _w(Lambda_re),
            "Lambda_im": _w(Lambda_im),
            "B_re": _w(B_re),
            "B_im": _w(B_im),
            "C_re": _w(C_re),
            "C_im": _w(C_im),
            "log_dt": _w(log_dt),
            "Dskip": _w(Dskip),
        }
    _A_in = _A_setup()

    def _B_setup():
        B, S, Dm, Df = 1, 2048, 512, 1376
        return {
            "x": _w((lambda *s: torch.randn(*s, dtype=torch.bfloat16) * 0.05)(B, S, Dm)),
            "w_gate": _w((lambda *s: torch.randn(*s, dtype=torch.bfloat16) * 0.4)(Dm, Df) * (Dm ** -0.5)),
            "w_up": _w((lambda *s: torch.randn(*s, dtype=torch.bfloat16) * 0.4)(Dm, Df) * (Dm ** -0.5)),
            "w_down": _w((lambda *s: torch.randn(*s, dtype=torch.bfloat16) * 0.4)(Df, Dm) * (Df ** -0.5)),
        }
    _B_in = _B_setup()

    return {
        "A_x": _A_in["x"],
        "A_Lambda_re": _A_in["Lambda_re"],
        "A_Lambda_im": _A_in["Lambda_im"],
        "A_B_re": _A_in["B_re"],
        "A_B_im": _A_in["B_im"],
        "A_C_re": _A_in["C_re"],
        "A_C_im": _A_in["C_im"],
        "A_log_dt": _A_in["log_dt"],
        "A_Dskip": _A_in["Dskip"],
        "B_x": _B_in["x"],
        "B_w_gate": _B_in["w_gate"],
        "B_w_up": _B_in["w_up"],
        "B_w_down": _B_in["w_down"],
    }

def reference(A_x, A_Lambda_re, A_Lambda_im, A_B_re, A_B_im, A_C_re, A_C_im, A_log_dt, A_Dskip, B_x, B_w_gate, B_w_up, B_w_down):
    def _A_ref(x, Lambda_re, Lambda_im, B_re, B_im, C_re, C_im, log_dt, Dskip):
        Bsz, L, H = x.shape
        Lam = Lambda_re + 1j * Lambda_im
        Bmat = B_re + 1j * B_im
        Cmat = C_re + 1j * C_im
        dt = torch.exp(log_dt)
        Lam_bar = torch.exp(dt * Lam)
        B_bar = ((Lam_bar - 1.0) / Lam)[:, None] * Bmat
        Bu = torch.einsum("bld,pd->blp", x + 0j, B_bar)
        h = torch.zeros_like(Bu[:, 0, :])
        hs = []
        for t in range(L):
            h = Lam_bar[None, :] * h + Bu[:, t, :]
            hs.append(h)
        hseq = torch.stack(hs, 1)
        y = 2.0 * torch.einsum("blp,dp->bld", hseq, Cmat).real + x * Dskip[None, None, :]
        return y

    def _B_ref(x, w_gate, w_up, w_down):
        g = torch.einsum("bsd,df->bsf", x, w_gate)
        u = torch.einsum("bsd,df->bsf", x, w_up)
        h = _gelu(g) * u
        return torch.einsum("bsf,fd->bsd", h, w_down)

    x = A_x
    xn = _layernorm(x, axis=-1)
    return x + _A_ref(xn, A_Lambda_re, A_Lambda_im, A_B_re, A_B_im, A_C_re, A_C_im, A_log_dt, A_Dskip) + _B_ref(xn, B_w_gate, B_w_up, B_w_down)
```

```asm
; @launch grid=(256,1,1) block=(256,1,1) lds=163840
.amdgcn_target "amdgcn-amd-amdhsa--gfx950"
.text
.globl parallel_sum__ssm_conv_s5__glu_gated_geglu__prompt_kernel
.p2align 8
.type parallel_sum__ssm_conv_s5__glu_gated_geglu__prompt_kernel,@function
parallel_sum__ssm_conv_s5__glu_gated_geglu__prompt_kernel:
    s_cmp_ge_u32 s2, 256
    s_cbranch_scc1 L_p1_end
    s_load_dwordx16 s[8:23], s[0:1], 0
    s_load_dwordx16 s[24:39], s[0:1], 64
    v_lshrrev_b32 v1, 6, v0
    v_and_b32 v2, 31, v0
    v_readfirstlane_b32 s5, v1
    v_and_b32 v1, 63, v0
    v_bfe_u32 v3, v0, 5, 1
    s_getpc_b64 s[68:69]
L_p1_pc:
    s_bfe_u32 s83, s2, 0x10003
    s_lshl_b32 s83, s83, 2
    s_add_u32 s83, s83, s5
    s_lshl_b32 s83, s83, 13
    v_lshlrev_b32 v44, 7, v1
    v_add_u32 v44, s83, v44
    v_min_u32 v44, 33900, v44
    v_mov_b32 v47, s69
    v_add_co_u32 v46, vcc, s68, v44
    s_nop 1
    v_addc_co_u32 v47, vcc, 0, v47, vcc
    global_load_dword v255, v[46:47], off
    s_and_b32 s3, s2, 1
    s_lshl_b32 s3, s3, 3
    s_bfe_u32 s83, s2, 0x30003
    s_add_u32 s3, s3, s83
    s_bfe_u32 s4, s2, 0x20001
    s_lshl_b32 s4, s4, 2
    s_lshr_b32 s83, s2, 6
    s_add_u32 s4, s4, s83
    v_and_b32 v46, 7, v1
    v_lshrrev_b32 v45, 4, v1
    v_xor_b32 v46, v46, v45
    v_lshlrev_b32 v46, 4, v46
    v_lshrrev_b32 v45, 3, v1
    v_lshl_add_u32 v5, v45, 10, v46
    v_xor_b32 v6, 64, v5
    v_add_u32 v7, 14336, v5
    v_add_u32 v8, 21504, v6
    v_add_u32 v6, 7168, v6
    s_lshl_b32 s80, s5, 12
    s_lshl_b32 s76, s3, 17
    s_lshl_b32 s83, s5, 15
    s_add_u32 s76, s76, s83
    s_mov_b32 s42, 2097152
    s_mov_b32 s43, 0x20000
    v_lshrrev_b32 v45, 2, v1
    s_movk_i32 s83, 2752
    v_mul_lo_u32 v45, v45, s83
    v_and_b32 v46, 3, v1
    v_lshl_add_u32 v9, v46, 4, v45
    v_add_u32 v10, 43008, v9
    v_add_u32 v11, 86016, v9
    v_add_u32 v12, 129024, v9
    s_and_b32 s6, s5, 1
    s_lshr_b32 s7, s5, 1
    s_mul_i32 s95, s4, 3
    s_add_u32 s96, s95, 1
    s_add_u32 s97, s95, 2
    s_lshl_b32 s82, s96, 11
    s_cmp_lt_u32 s4, 11
    s_cbranch_scc1 L_p1_u
    s_lshl_b32 s95, s4, 1
    s_add_u32 s95, s95, 11
    s_add_u32 s97, s95, 1
    s_mov_b32 s96, s95
    s_mov_b32 s82, 0x10000000
L_p1_u:
    s_and_b32 s101, s3, 7
    s_lshl_b32 s101, s101, 7
    s_mov_b32 s100, s101
    s_mov_b32 s47, 0x20000
    s_waitcnt lgkmcnt(0)
    s_mov_b32 s40, s8
    s_mov_b32 s41, s9
    s_add_u32 s99, s76, s101
    s_add_u32 m0, s80, 0
    s_nop 0
    buffer_load_dwordx4 v5, s[40:43], s99 offen offset:0 lds
    buffer_load_dwordx4 v6, s[40:43], s99 offen offset:1024 lds
    buffer_load_dwordx4 v7, s[40:43], s99 offen offset:2048 lds
    buffer_load_dwordx4 v8, s[40:43], s99 offen offset:3072 lds
    s_cmp_lt_u32 s5, 2
    s_cbranch_scc0 L_p1_wffn
    s_cmp_eq_u32 s5, 0
    s_cselect_b32 s44, s14, s16
    s_cselect_b32 s45, s15, s17
    s_mov_b32 s46, 524288
    s_movk_i32 s78, 1
    s_lshl_b32 s77, s4, 15
    v_mov_b32 v13, v5
    v_mov_b32 v14, v6
    v_mov_b32 v15, v7
    v_mov_b32 v16, v8
    s_branch L_p1_wdone
L_p1_wffn:
    s_cmp_eq_u32 s5, 2
    s_cselect_b32 s44, s28, s30
    s_cselect_b32 s45, s29, s31
    s_mov_b32 s46, 1409024
    s_movk_i32 s78, 1376
    s_lshl_b32 s77, s95, 6
    v_mov_b32 v13, v9
    v_mov_b32 v14, v10
    v_mov_b32 v15, v11
    v_mov_b32 v16, v12
L_p1_wdone:
    s_mul_i32 s99, s101, s78
    s_add_u32 s99, s99, s77
    s_add_u32 m0, s80, 65536
    s_nop 0
    buffer_load_dwordx4 v13, s[44:47], s99 offen offset:0 lds
    buffer_load_dwordx4 v14, s[44:47], s99 offen offset:1024 lds
    buffer_load_dwordx4 v15, s[44:47], s99 offen offset:2048 lds
    buffer_load_dwordx4 v16, s[44:47], s99 offen offset:3072 lds
    s_add_u32 s101, s101, 128
    s_and_b32 s101, s101, 1023
    s_mov_b32 s64, s36
    s_mov_b32 s65, s37
    s_mov_b32 s66, 256
    s_mov_b32 s67, 0x20000
    s_or_b32 s83, s2, s5
    s_cmp_lg_u32 s83, 0
    s_cbranch_scc1 L_p1_nn
    s_memrealtime s[90:91]
    s_waitcnt lgkmcnt(0)
    s_or_b32 s90, s90, 1
    v_mov_b32 v44, s90
    buffer_store_dword v44, off, s[64:67], 0 sc1
L_p1_nn:
    s_add_u32 s99, s76, s101
    s_add_u32 m0, s80, 16384
    s_nop 0
    buffer_load_dwordx4 v5, s[40:43], s99 offen offset:0 lds
    buffer_load_dwordx4 v6, s[40:43], s99 offen offset:1024 lds
    buffer_load_dwordx4 v7, s[40:43], s99 offen offset:2048 lds
    buffer_load_dwordx4 v8, s[40:43], s99 offen offset:3072 lds
    s_mul_i32 s99, s101, s78
    s_add_u32 s99, s99, s77
    s_add_u32 m0, s80, 81920
    s_nop 0
    buffer_load_dwordx4 v13, s[44:47], s99 offen offset:0 lds
    buffer_load_dwordx4 v14, s[44:47], s99 offen offset:1024 lds
    buffer_load_dwordx4 v15, s[44:47], s99 offen offset:2048 lds
    buffer_load_dwordx4 v16, s[44:47], s99 offen offset:3072 lds
    s_add_u32 s101, s101, 128
    s_and_b32 s101, s101, 1023
    v_lshlrev_b32 v47, 4, v1
    s_lshl_b32 s92, s3, 17
    s_lshl_b32 s83, s4, 13
    s_add_u32 s92, s92, s83
    s_lshl_b32 s83, s5, 11
    s_add_u32 s92, s92, s83
    buffer_load_dwordx4 v[64:67], v47, s[40:43], s92 offen
    buffer_load_dwordx4 v[68:71], v47, s[40:43], s92 offen offset:1024
    s_lshr_b32 s92, s3, 1
    s_and_b32 s94, s3, 1
    s_lshl_b32 s94, s94, 2
    s_add_u32 s94, s94, s5
    s_add_u32 m0, s80, 131072
    s_cmp_lt_u32 s92, 2
    s_cbranch_scc0 L_p1_c0ffn
    s_cmp_eq_u32 s92, 0
    s_cselect_b32 s68, s14, s16
    s_cselect_b32 s69, s15, s17
    s_mov_b32 s70, 524288
    s_mov_b32 s71, 0x20000
    s_lshl_b32 s83, s4, 15
    s_lshl_b32 s84, s94, 7
    s_add_u32 s83, s83, s84
    buffer_load_dwordx4 v5, s[68:71], s83 offen offset:0 lds
    buffer_load_dwordx4 v6, s[68:71], s83 offen offset:1024 lds
    buffer_load_dwordx4 v7, s[68:71], s83 offen offset:2048 lds
    buffer_load_dwordx4 v8, s[68:71], s83 offen offset:3072 lds
    s_branch L_p1_c0done
L_p1_c0ffn:
    s_bitcmp1_b32 s92, 0
    s_cselect_b32 s68, s30, s28
    s_cselect_b32 s69, s31, s29
    s_mov_b32 s70, 1409024
    s_mov_b32 s71, 0x20000
    s_lshr_b32 s84, s92, 1
    s_cmp_eq_u32 s84, 1
    s_cselect_b32 s83, s95, s97
    s_cmp_eq_u32 s84, 2
    s_cselect_b32 s83, s96, s83
    s_lshl_b32 s83, s83, 6
    s_mul_i32 s84, s94, 176128
    s_add_u32 s83, s83, s84
    buffer_load_dwordx4 v9, s[68:71], s83 offen offset:0 lds
    buffer_load_dwordx4 v10, s[68:71], s83 offen offset:1024 lds
    buffer_load_dwordx4 v11, s[68:71], s83 offen offset:2048 lds
    buffer_load_dwordx4 v12, s[68:71], s83 offen offset:3072 lds
L_p1_c0done:
    s_lshl_b32 s83, s4, 6
    v_lshl_add_u32 v44, v2, 1, s83
    s_movk_i32 s74, 1024
    s_mov_b32 s75, 0x20000
    s_mov_b32 s72, s10
    s_mov_b32 s73, s11
    buffer_load_ushort v88, v44, s[72:75], 0 offen
    s_mov_b32 s72, s12
    s_mov_b32 s73, s13
    buffer_load_ushort v89, v44, s[72:75], 0 offen
    s_mov_b32 s72, s22
    s_mov_b32 s73, s23
    buffer_load_ushort v90, v44, s[72:75], 0 offen
    buffer_load_dword v91, off, s[64:67], 0 sc1
    v_bfe_u32 v4, v2, 2, 1
    v_lshlrev_b32 v4, 4, v4
    v_lshrrev_b32 v46, 3, v2
    v_lshl_add_u32 v4, v46, 2, v4
    v_and_b32 v46, 3, v2
    v_add_u32 v4, v4, v46
    v_bfe_u32 v46, v4, 1, 3
    s_lshl_b32 s83, s6, 13
    v_lshlrev_b32 v45, 7, v4
    v_add_u32 v45, s83, v45
    v_or_b32 v44, 0, v3
    v_xor_b32 v44, v44, v46
    v_lshl_add_u32 v19, v44, 4, v45
    v_or_b32 v44, 2, v3
    v_xor_b32 v44, v44, v46
    v_lshl_add_u32 v20, v44, 4, v45
    v_or_b32 v44, 4, v3
    v_xor_b32 v44, v44, v46
    v_lshl_add_u32 v21, v44, 4, v45
    v_or_b32 v44, 6, v3
    v_xor_b32 v44, v44, v46
    v_lshl_add_u32 v22, v44, 4, v45
    v_bfe_u32 v46, v2, 1, 3
    v_lshlrev_b32 v45, 7, v2
    v_or_b32 v44, 0, v3
    v_xor_b32 v44, v44, v46
    v_lshl_add_u32 v84, v44, 4, v45
    v_add_u32 v23, 65536, v84
    v_or_b32 v44, 2, v3
    v_xor_b32 v44, v44, v46
    v_lshl_add_u32 v85, v44, 4, v45
    v_add_u32 v24, 65536, v85
    v_or_b32 v44, 4, v3
    v_xor_b32 v44, v44, v46
    v_lshl_add_u32 v86, v44, 4, v45
    v_add_u32 v25, 65536, v86
    v_or_b32 v44, 6, v3
    v_xor_b32 v44, v44, v46
    v_lshl_add_u32 v87, v44, 4, v45
    v_add_u32 v26, 65536, v87
    v_bfe_u32 v44, v1, 2, 2
    v_lshl_add_u32 v44, v3, 3, v44
    v_lshlrev_b32 v44, 6, v44
    v_bfe_u32 v45, v1, 4, 1
    v_lshl_add_u32 v44, v45, 5, v44
    v_and_b32 v45, 3, v1
    v_lshl_add_u32 v17, v45, 3, v44
    s_lshl_b32 s83, s7, 13
    s_add_u32 s83, s83, 65536
    v_add_u32 v18, s83, v17
    s_mov_b32 s88, 0
    s_mov_b32 s89, -1
    s_mov_b32 s86, 0xffff0000
    s_cmp_eq_u32 s7, 1
    s_cbranch_scc1 L_p1_role1
    s_waitcnt vmcnt(18)
    s_barrier
    ds_read_b128 a[0:3], v19 offset:0
    ds_read_b128 a[128:131], v19 offset:4096
    ds_read_b128 v[96:99], v23 offset:0
    ds_read_b128 v[100:103], v23 offset:4096
    ds_read_b128 a[4:7], v20 offset:0
    ds_read_b128 a[132:135], v20 offset:4096
    ds_read_b128 v[104:107], v24 offset:0
    ds_read_b128 v[108:111], v24 offset:4096
    ds_read_b128 a[8:11], v21 offset:0
    ds_read_b128 a[136:139], v21 offset:4096
    ds_read_b128 v[112:115], v25 offset:0
    ds_read_b128 v[116:119], v25 offset:4096
    s_waitcnt lgkmcnt(9)
    v_mfma_f32_32x32x16_bf16 v[128:143], a[0:3], v[96:99], 0
    s_add_u32 s99, s76, s101
    s_add_u32 m0, s80, 32768
    s_nop 0
    buffer_load_dwordx4 v5, s[40:43], s99 offen offset:0 lds
    s_bitcmp1_b32 s5, 1
    s_cselect_b32 s48, s30, s28
    s_cselect_b32 s49, s31, s29
    s_mov_b32 s50, 1409024
    s_mov_b32 s51, 0x20000
    v_mfma_f32_32x32x16_bf16 v[160:175], a[128:131], v[96:99], 0
    buffer_load_dwordx4 v6, s[40:43], s99 offen offset:1024 lds
    s_lshl_b32 s79, s96, 6
    s_mul_i32 s83, s6, 88064
    s_add_u32 s79, s79, s83
    v_lshrrev_b32 v45, 3, v1
    s_movk_i32 s83, 2752
    s_waitcnt lgkmcnt(8)
    v_mfma_f32_32x32x16_bf16 v[144:159], a[0:3], v[100:103], 0
    buffer_load_dwordx4 v7, s[40:43], s99 offen offset:2048 lds
    v_mul_lo_u32 v45, v45, s83
    v_bfe_u32 v46, v1, 4, 1
    v_lshlrev_b32 v46, 2, v46
    v_and_b32 v44, 7, v1
    v_xor_b32 v46, v46, v44
    v_mfma_f32_32x32x16_bf16 v[176:191], a[128:131], v[100:103], 0
    buffer_load_dwordx4 v8, s[40:43], s99 offen offset:3072 lds
    v_lshl_add_u32 v9, v46, 4, v45
    v_add_u32 v10, 20992, v9
    v_add_u32 v11, 41984, v9
    v_add_u32 v12, 62976, v9
    s_add_u32 s60, s38, 13631488
    s_addc_u32 s61, s39, 0
    ds_read_b128 a[12:15], v22 offset:0
    ds_read_b128 a[140:143], v22 offset:4096
    ds_read_b128 v[120:123], v26 offset:0
    ds_read_b128 v[124:127], v26 offset:4096
    s_waitcnt lgkmcnt(9)
    v_mfma_f32_32x32x16_bf16 v[128:143], a[4:7], v[104:107], v[128:143]
    s_mul_i32 s99, s101, s78
    s_add_u32 s99, s99, s77
    s_add_u32 m0, s80, 98304
    s_nop 0
    buffer_load_dwordx4 v13, s[44:47], s99 offen offset:0 lds
    s_mov_b32 s62, 458752
    s_mov_b32 s63, 0x20000
    s_lshl_b32 s81, s95, 11
    s_lshl_b32 s83, s97, 11
    s_cmp_eq_u32 s7, 0
    s_cselect_b32 s82, s82, s83
    v_mfma_f32_32x32x16_bf16 v[160:175], a[132:135], v[104:107], v[160:175]
    buffer_load_dwordx4 v14, s[44:47], s99 offen offset:1024 lds
    v_lshlrev_b32 v27, 4, v4
    v_lshl_add_u32 v27, v3, 9, v27
    v_bfe_u32 v44, v1, 2, 2
    s_waitcnt lgkmcnt(8)
    v_mfma_f32_32x32x16_bf16 v[144:159], a[4:7], v[108:111], v[144:159]
    buffer_load_dwordx4 v15, s[44:47], s99 offen offset:2048 lds
    v_lshl_add_u32 v44, v3, 3, v44
    v_lshlrev_b32 v44, 7, v44
    v_bfe_u32 v45, v1, 4, 1
    v_lshlrev_b32 v45, 1, v45
    v_bfe_u32 v46, v1, 1, 1
    v_mfma_f32_32x32x16_bf16 v[176:191], a[132:135], v[108:111], v[176:191]
    buffer_load_dwordx4 v16, s[44:47], s99 offen offset:3072 lds
    s_add_u32 s101, s101, 128
    s_and_b32 s101, s101, 1023
    v_add_u32 v45, v45, v46
    s_lshl_b32 s83, s7, 2
    v_add_u32 v45, s83, v45
    v_bfe_u32 v46, v1, 3, 1
    v_lshlrev_b32 v46, 2, v46
    s_waitcnt lgkmcnt(0)
    v_mfma_f32_32x32x16_bf16 v[128:143], a[8:11], v[112:115], v[128:143]
    s_waitcnt vmcnt(18)
    s_barrier
    ds_read_b128 a[16:19], v19 offset:16384
    ds_read_b128 a[144:147], v19 offset:20480
    ds_read_b128 v[96:99], v23 offset:16384
    ds_read_b128 v[100:103], v23 offset:20480
    s_add_u32 s99, s76, s101
    s_add_u32 m0, s80, 49152
    s_nop 0
    buffer_load_dwordx4 v5, s[40:43], s99 offen offset:0 lds
    v_xor_b32 v45, v45, v46
    v_lshl_add_u32 v44, v45, 4, v44
    v_and_b32 v45, 1, v1
    v_lshl_add_u32 v34, v45, 3, v44
    v_add_u32 v35, 65536, v34
    v_mfma_f32_32x32x16_bf16 v[160:175], a[136:139], v[112:115], v[160:175]
    buffer_load_dwordx4 v6, s[40:43], s99 offen offset:1024 lds
    s_lshl_b32 s83, s3, 2
    s_lshl_b32 s84, s6, 1
    s_add_u32 s83, s83, s84
    s_mul_i32 s83, s83, 153600
    s_add_u32 s52, s38, s83
    s_addc_u32 s53, s39, 0
    v_mfma_f32_32x32x16_bf16 v[144:159], a[8:11], v[116:119], v[144:159]
    buffer_load_dwordx4 v7, s[40:43], s99 offen offset:2048 lds
    s_add_u32 s56, s52, 153600
    s_addc_u32 s57, s53, 0
    s_mov_b32 s54, 153600
    s_mov_b32 s55, 0x20000
    v_mfma_f32_32x32x16_bf16 v[176:191], a[136:139], v[116:119], v[176:191]
    buffer_load_dwordx4 v8, s[40:43], s99 offen offset:3072 lds
    s_mov_b32 s58, 153600
    s_mov_b32 s59, 0x20000
    v_mov_b32 v38, 0
    v_mov_b32 v39, 0
    v_mov_b32 v42, 0
    ds_read_b128 a[20:23], v20 offset:16384
    ds_read_b128 a[148:151], v20 offset:20480
    ds_read_b128 v[104:107], v24 offset:16384
    ds_read_b128 v[108:111], v24 offset:20480
    v_mfma_f32_32x32x16_bf16 v[128:143], a[12:15], v[120:123], v[128:143]
    s_mul_i32 s99, s101, s78
    s_add_u32 s99, s99, s77
    s_add_u32 m0, s80, 114688
    s_nop 0
    buffer_load_dwordx4 v13, s[44:47], s99 offen offset:0 lds
    v_mov_b32 v43, 0
    v_mov_b32 v46, 0
    v_mov_b32 v47, 0
    v_mov_b32 v50, 0
    v_mov_b32 v51, 0
    v_mfma_f32_32x32x16_bf16 v[160:175], a[140:143], v[120:123], v[160:175]
    buffer_load_dwordx4 v14, s[44:47], s99 offen offset:1024 lds
    v_mov_b32 v72, 0
    v_mov_b32 v73, 0
    v_mov_b32 v74, 0
    v_mov_b32 v75, 0
    s_waitcnt vmcnt(23)
    v_lshlrev_b32 v76, 16, v64
    v_mfma_f32_32x32x16_bf16 v[144:159], a[12:15], v[124:127], v[144:159]
    buffer_load_dwordx4 v15, s[44:47], s99 offen offset:2048 lds
    v_and_b32 v77, s86, v64
    v_add_f32 v72, v72, v76
    v_fmac_f32 v73, v76, v76
    v_add_f32 v72, v72, v77
    v_fmac_f32 v73, v77, v77
    v_mfma_f32_32x32x16_bf16 v[176:191], a[140:143], v[124:127], v[176:191]
    buffer_load_dwordx4 v16, s[44:47], s99 offen offset:3072 lds
    s_add_u32 s101, s101, 128
    s_and_b32 s101, s101, 1023
    s_waitcnt vmcnt(24)
    v_lshlrev_b32 v78, 16, v68
    v_and_b32 v79, s86, v68
    v_add_f32 v74, v74, v78
    v_fmac_f32 v75, v78, v78
    v_add_f32 v74, v74, v79
    ds_read_b128 a[24:27], v21 offset:16384
    ds_read_b128 a[152:155], v21 offset:20480
    ds_read_b128 v[112:115], v25 offset:16384
    ds_read_b128 v[116:119], v25 offset:20480
    s_waitcnt lgkmcnt(9)
    v_mfma_f32_32x32x16_bf16 v[128:143], a[16:19], v[96:99], v[128:143]
    s_add_u32 s99, s76, s101
    s_add_u32 m0, s80, 0
    s_nop 0
    buffer_load_dwordx4 v5, s[40:43], s99 offen offset:0 lds
    v_fmac_f32 v75, v79, v79
    v_lshlrev_b32 v76, 16, v65
    v_and_b32 v77, s86, v65
    v_add_f32 v72, v72, v76
    v_fmac_f32 v73, v76, v76
    v_mfma_f32_32x32x16_bf16 v[160:175], a[144:147], v[96:99], v[160:175]
    buffer_load_dwordx4 v6, s[40:43], s99 offen offset:1024 lds
    v_add_f32 v72, v72, v77
    v_fmac_f32 v73, v77, v77
    v_lshlrev_b32 v78, 16, v69
    v_and_b32 v79, s86, v69
    v_add_f32 v74, v74, v78
    s_waitcnt lgkmcnt(8)
    v_mfma_f32_32x32x16_bf16 v[144:159], a[16:19], v[100:103], v[144:159]
    buffer_load_dwordx4 v7, s[40:43], s99 offen offset:2048 lds
    v_fmac_f32 v75, v78, v78
    v_add_f32 v74, v74, v79
    v_fmac_f32 v75, v79, v79
    v_lshlrev_b32 v76, 16, v66
    v_and_b32 v77, s86, v66
    v_mfma_f32_32x32x16_bf16 v[176:191], a[144:147], v[100:103], v[176:191]
    buffer_load_dwordx4 v8, s[40:43], s99 offen offset:3072 lds
    v_add_f32 v72, v72, v76
    v_fmac_f32 v73, v76, v76
    v_add_f32 v72, v72, v77
    v_fmac_f32 v73, v77, v77
    v_lshlrev_b32 v78, 16, v70
    ds_read_b128 a[28:31], v22 offset:16384
    ds_read_b128 a[156:159], v22 offset:20480
    ds_read_b128 v[120:123], v26 offset:16384
    ds_read_b128 v[124:127], v26 offset:20480
    s_waitcnt lgkmcnt(9)
    v_mfma_f32_32x32x16_bf16 v[128:143], a[20:23], v[104:107], v[128:143]
    s_mul_i32 s99, s101, s78
    s_add_u32 s99, s99, s77
    s_add_u32 m0, s80, 65536
    s_nop 0
    buffer_load_dwordx4 v13, s[44:47], s99 offen offset:0 lds
    v_and_b32 v79, s86, v70
    v_add_f32 v74, v74, v78
    v_fmac_f32 v75, v78, v78
    v_add_f32 v74, v74, v79
    v_fmac_f32 v75, v79, v79
    v_mfma_f32_32x32x16_bf16 v[160:175], a[148:151], v[104:107], v[160:175]
    buffer_load_dwordx4 v14, s[44:47], s99 offen offset:1024 lds
    v_lshlrev_b32 v76, 16, v67
    v_and_b32 v77, s86, v67
    v_add_f32 v72, v72, v76
    v_fmac_f32 v73, v76, v76
    v_add_f32 v72, v72, v77
    s_waitcnt lgkmcnt(8)
    v_mfma_f32_32x32x16_bf16 v[144:159], a[20:23], v[108:111], v[144:159]
    buffer_load_dwordx4 v15, s[44:47], s99 offen offset:2048 lds
    v_fmac_f32 v73, v77, v77
    v_lshlrev_b32 v78, 16, v71
    v_and_b32 v79, s86, v71
    v_add_f32 v74, v74, v78
    v_fmac_f32 v75, v78, v78
    v_mfma_f32_32x32x16_bf16 v[176:191], a[148:151], v[108:111], v[176:191]
    buffer_load_dwordx4 v16, s[44:47], s99 offen offset:3072 lds
    s_add_u32 s101, s101, 128
    s_and_b32 s101, s101, 1023
    v_add_f32 v74, v74, v79
    v_fmac_f32 v75, v79, v79
    v_add_f32_dpp v72, v72, v72 row_shr:1 bound_ctrl:0
    v_add_f32_dpp v73, v73, v73 row_shr:1 bound_ctrl:0
    v_add_f32_dpp v74, v74, v74 row_shr:1 bound_ctrl:0
    s_waitcnt lgkmcnt(0)
    v_mfma_f32_32x32x16_bf16 v[128:143], a[24:27], v[112:115], v[128:143]
    v_add_f32_dpp v75, v75, v75 row_shr:1 bound_ctrl:0
    v_add_f32_dpp v72, v72, v72 row_shr:2 bound_ctrl:0
    v_add_f32_dpp v73, v73, v73 row_shr:2 bound_ctrl:0
    v_add_f32_dpp v74, v74, v74 row_shr:2 bound_ctrl:0
    v_add_f32_dpp v75, v75, v75 row_shr:2 bound_ctrl:0
    v_add_f32_dpp v72, v72, v72 row_shr:4 bound_ctrl:0
    v_add_f32_dpp v73, v73, v73 row_shr:4 bound_ctrl:0
    v_add_f32_dpp v74, v74, v74 row_shr:4 bound_ctrl:0
    v_add_f32_dpp v75, v75, v75 row_shr:4 bound_ctrl:0
    v_add_f32_dpp v72, v72, v72 row_shr:8 bound_ctrl:0
    v_add_f32_dpp v73, v73, v73 row_shr:8 bound_ctrl:0
    v_add_f32_dpp v74, v74, v74 row_shr:8 bound_ctrl:0
    v_add_f32_dpp v75, v75, v75 row_shr:8 bound_ctrl:0
    v_add_f32_dpp v72, v72, v72 row_bcast:15 row_mask:0xa
    v_add_f32_dpp v73, v73, v73 row_bcast:15 row_mask:0xa
    v_add_f32_dpp v74, v74, v74 row_bcast:15 row_mask:0xa
    v_add_f32_dpp v75, v75, v75 row_bcast:15 row_mask:0xa
    v_add_f32_dpp v72, v72, v72 row_bcast:31 row_mask:0xc
    v_add_f32_dpp v73, v73, v73 row_bcast:31 row_mask:0xc
    v_add_f32_dpp v74, v74, v74 row_bcast:31 row_mask:0xc
    v_add_f32_dpp v75, v75, v75 row_bcast:31 row_mask:0xc
    v_mul_f32 v72, 0x3b000000, v72
    v_mul_f32 v74, 0x3b000000, v74
    v_mul_f32 v73, 0x3b000000, v73
    v_mul_f32 v75, 0x3b000000, v75
    v_fma_f32 v73, -v72, v72, v73
    v_fma_f32 v75, -v74, v74, v75
    v_max_f32 v73, 0, v73
    v_max_f32 v75, 0, v75
    v_cvt_pk_bf16_f32 v76, v72, v72
    v_cvt_pk_bf16_f32 v77, v74, v74
    v_lshlrev_b32 v72, 16, v76
    v_lshlrev_b32 v74, 16, v77
    v_cvt_pk_bf16_f32 v76, v73, v73
    v_cvt_pk_bf16_f32 v77, v75, v75
    v_lshlrev_b32 v73, 16, v76
    v_lshlrev_b32 v75, 16, v77
    v_add_f32 v73, 0x3727c5ac, v73
    v_add_f32 v75, 0x3727c5ac, v75
    v_cvt_pk_bf16_f32 v76, v73, v73
    v_cvt_pk_bf16_f32 v77, v75, v75
    v_lshlrev_b32 v73, 16, v76
    v_lshlrev_b32 v75, 16, v77
    v_sqrt_f32 v73, v73
    v_sqrt_f32 v75, v75
    v_cvt_pk_bf16_f32 v76, v73, v73
    v_cvt_pk_bf16_f32 v77, v75, v75
    v_lshlrev_b32 v73, 16, v76
    v_lshlrev_b32 v75, 16, v77
    v_rcp_f32 v73, v73
    v_rcp_f32 v75, v75
    s_nop 0
    v_mov_b32 v78, v75
    v_mov_b32 v76, v74
    v_mov_b32 v74, v73
    s_waitcnt vmcnt(28)
    v_mov_b32 v80, 0x3f803f80
    v_mov_b32 v81, v80
    v_mov_b32 v82, v80
    v_mov_b32 v83, v80
    s_add_u32 s92, s80, 131072
    s_cmp_lt_u32 s3, 4
    s_cbranch_scc0 L_p1_c1ffn0
    v_add_u32 v84, s92, v84
    ds_read_b128 v[192:195], v84
    v_add_u32 v85, s92, v85
    ds_read_b128 v[196:199], v85
    v_add_u32 v86, s92, v86
    ds_read_b128 v[200:203], v86
    v_add_u32 v87, s92, v87
    ds_read_b128 v[204:207], v87
    s_branch L_p1_c1done0
L_p1_c1ffn0:
    v_add_u32 v84, s92, v17
    s_waitcnt lgkmcnt(3)
    ds_read_b64_tr_b16 v[192:193], v84 offset:0
    ds_read_b64_tr_b16 v[194:195], v84 offset:256
    s_waitcnt lgkmcnt(4)
    ds_read_b64_tr_b16 v[196:197], v84 offset:1024
    ds_read_b64_tr_b16 v[198:199], v84 offset:1280
    s_waitcnt lgkmcnt(5)
    ds_read_b64_tr_b16 v[200:201], v84 offset:2048
    ds_read_b64_tr_b16 v[202:203], v84 offset:2304
    s_waitcnt lgkmcnt(6)
    ds_read_b64_tr_b16 v[204:205], v84 offset:3072
    ds_read_b64_tr_b16 v[206:207], v84 offset:3328
L_p1_c1done0:
    s_waitcnt lgkmcnt(0)
    v_mfma_f32_32x32x16_bf16 v[224:239], v[80:83], v[192:195], 0
    v_mfma_f32_32x32x16_bf16 v[224:239], v[80:83], v[196:199], v[224:239]
    v_mfma_f32_32x32x16_bf16 v[224:239], v[80:83], v[200:203], v[224:239]
    v_mfma_f32_32x32x16_bf16 v[224:239], v[80:83], v[204:207], v[224:239]
    s_waitcnt vmcnt(16)
    s_barrier
    ds_read_b128 a[32:35], v19 offset:32768
    ds_read_b128 a[160:163], v19 offset:36864
    ds_read_b128 v[96:99], v23 offset:32768
    ds_read_b128 v[100:103], v23 offset:36864
    s_add_u32 s99, s76, s101
    s_add_u32 m0, s80, 16384
    s_nop 0
    buffer_load_dwordx4 v5, s[40:43], s99 offen offset:0 lds
    s_lshl_b32 s92, s5, 7
    v_lshlrev_b32 v84, 2, v2
    v_add_u32 v84, s92, v84
    v_add_u32 v84, 150016, v84
    ds_write_b32 v84, v224
    v_mfma_f32_32x32x16_bf16 v[160:175], a[152:155], v[112:115], v[160:175]
    buffer_load_dwordx4 v6, s[40:43], s99 offen offset:1024 lds
    v_lshlrev_b32 v88, 16, v88
    v_lshlrev_b32 v89, 16, v89
    v_lshlrev_b32 v90, 16, v90
    v_mul_f32 v92, 0x3fb8aa3b, v90
    v_exp_f32 v92, v92
    v_mfma_f32_32x32x16_bf16 v[144:159], a[24:27], v[116:119], v[144:159]
    buffer_load_dwordx4 v7, s[40:43], s99 offen offset:2048 lds
    v_cvt_pk_bf16_f32 v93, v92, v92
    v_lshlrev_b32 v92, 16, v93
    v_mul_f32 v93, v92, v88
    v_mul_f32 v94, v92, v89
    v_mul_f32 v93, 0x3fb8aa3b, v93
    v_mfma_f32_32x32x16_bf16 v[176:191], a[152:155], v[116:119], v[176:191]
    buffer_load_dwordx4 v8, s[40:43], s99 offen offset:3072 lds
    v_exp_f32 v93, v93
    v_mul_f32 v94, 0.15915494, v94
    v_fract_f32 v94, v94
    v_cos_f32 v95, v94
    v_sin_f32 v94, v94
    ds_read_b128 a[36:39], v20 offset:32768
    ds_read_b128 a[164:167], v20 offset:36864
    ds_read_b128 v[104:107], v24 offset:32768
    ds_read_b128 v[108:111], v24 offset:36864
    v_mfma_f32_32x32x16_bf16 v[128:143], a[28:31], v[120:123], v[128:143]
    s_mul_i32 s99, s101, s78
    s_add_u32 s99, s99, s77
    s_add_u32 m0, s80, 81920
    s_nop 0
    buffer_load_dwordx4 v13, s[44:47], s99 offen offset:0 lds
    v_mul_f32 v52, v93, v95
    v_mul_f32 v53, v93, v94
    v_add_f32 v92, -1.0, v52
    v_mul_f32 v93, v88, v88
    v_fmac_f32 v93, v89, v89
    v_mfma_f32_32x32x16_bf16 v[160:175], a[156:159], v[120:123], v[160:175]
    buffer_load_dwordx4 v14, s[44:47], s99 offen offset:1024 lds
    v_rcp_f32 v93, v93
    s_nop 0
    v_add_f32 v93, v93, v93
    v_mul_f32 v94, v92, v88
    v_fmac_f32 v94, v53, v89
    v_mul_f32 v58, v94, v93
    v_mfma_f32_32x32x16_bf16 v[144:159], a[28:31], v[124:127], v[144:159]
    buffer_load_dwordx4 v15, s[44:47], s99 offen offset:2048 lds
    v_mul_f32 v94, v53, v88
    v_fma_f32 v94, -v92, v89, v94
    v_mul_f32 v59, v94, v93
    v_mov_b32 v54, v52
    v_mov_b32 v55, v53
    v_mfma_f32_32x32x16_bf16 v[176:191], a[156:159], v[124:127], v[176:191]
    buffer_load_dwordx4 v16, s[44:47], s99 offen offset:3072 lds
    s_add_u32 s101, s101, 128
    s_and_b32 s101, s101, 1023
    v_mul_f32 v92, v55, v55
    v_mul_f32 v55, v54, v55
    v_fma_f32 v54, v54, v54, -v92
    v_add_f32 v55, v55, v55
    v_mul_f32 v92, v55, v55
    ds_read_b128 a[40:43], v21 offset:32768
    ds_read_b128 a[168:171], v21 offset:36864
    ds_read_b128 v[112:115], v25 offset:32768
    ds_read_b128 v[116:119], v25 offset:36864
    s_waitcnt lgkmcnt(10)
    v_mfma_f32_32x32x16_bf16 v[128:143], a[32:35], v[96:99], v[128:143]
    v_mul_f32 v55, v54, v55
    v_fma_f32 v54, v54, v54, -v92
    v_add_f32 v55, v55, v55
    v_mul_f32 v92, v55, v55
    v_mul_f32 v55, v54, v55
    v_mfma_f32_32x32x16_bf16 v[160:175], a[160:163], v[96:99], v[160:175]
    v_fma_f32 v54, v54, v54, -v92
    v_add_f32 v55, v55, v55
    v_mul_f32 v92, v55, v55
    v_mul_f32 v55, v54, v55
    v_fma_f32 v54, v54, v54, -v92
    s_waitcnt lgkmcnt(9)
    v_mfma_f32_32x32x16_bf16 v[144:159], a[32:35], v[100:103], v[144:159]
    v_add_f32 v55, v55, v55
    v_mov_b32 v88, v54
    v_mov_b32 v89, v55
    v_mul_f32 v92, v89, v89
    v_mul_f32 v89, v88, v89
    v_mfma_f32_32x32x16_bf16 v[176:191], a[160:163], v[100:103], v[176:191]
    v_fma_f32 v88, v88, v88, -v92
    v_add_f32 v89, v89, v89
    v_mov_b32 v94, v88
    v_mov_b32 v95, v89
    v_mul_f32 v92, v95, v95
    ds_read_b128 a[44:47], v22 offset:32768
    ds_read_b128 a[172:175], v22 offset:36864
    ds_read_b128 v[120:123], v26 offset:32768
    ds_read_b128 v[124:127], v26 offset:36864
    s_waitcnt lgkmcnt(9)
    v_mfma_f32_32x32x16_bf16 v[128:143], a[36:39], v[104:107], v[128:143]
    v_mul_f32 v95, v94, v95
    v_fma_f32 v94, v94, v94, -v92
    v_add_f32 v95, v95, v95
    v_mov_b32 v56, v94
    v_mov_b32 v57, v95
    v_mfma_f32_32x32x16_bf16 v[160:175], a[164:167], v[104:107], v[160:175]
    v_mul_f32 v92, v57, v57
    v_mul_f32 v57, v56, v57
    v_fma_f32 v56, v56, v56, -v92
    v_add_f32 v57, v57, v57
    s_cmp_eq_u32 s6, 1
    s_cselect_b32 s87, 1.0, 0
    s_cselect_b32 s90, -1, 0
    s_cselect_b32 s84, 0, 1.0
    s_waitcnt lgkmcnt(8)
    v_mfma_f32_32x32x16_bf16 v[144:159], a[36:39], v[108:111], v[144:159]
    s_mov_b32 s91, 0
    v_mul_f32 v94, s87, v94
    v_mfma_f32_32x32x16_bf16 v[176:191], a[164:167], v[108:111], v[176:191]
    v_mul_f32 v95, s87, v95
    v_add_f32 v94, s84, v94
    v_mul_f32 v92, v94, v54
    v_mul_f32 v93, v94, v55
    v_fma_f32 v92, -v95, v55, v92
    s_waitcnt lgkmcnt(0)
    v_mfma_f32_32x32x16_bf16 v[128:143], a[40:43], v[112:115], v[128:143]
    v_fmac_f32 v93, v95, v54
    v_cndmask_b32 v60, v94, v92, s[88:89]
    v_cndmask_b32 v61, v95, v93, s[88:89]
    v_mul_f32 v62, v60, v88
    v_mul_f32 v63, v60, v89
    v_fma_f32 v62, -v61, v89, v62
    v_fmac_f32 v63, v61, v88
    s_cmp_lg_u32 s5, 0
    s_cbranch_scc1 L_p1_n0skip
    v_readfirstlane_b32 s92, v91
    s_cmp_eq_u32 s92, 0
    s_cbranch_scc1 L_p1_nslow
L_p1_nok:
    v_mov_b32 v92, 150528
    ds_write_b32 v92, v91
L_p1_n0skip:
    s_waitcnt lgkmcnt(0)
    s_waitcnt vmcnt(16)
    s_barrier
    ds_read_b128 a[48:51], v19 offset:49152
    ds_read_b128 a[176:179], v19 offset:53248
    ds_read_b128 v[96:99], v23 offset:49152
    ds_read_b128 v[100:103], v23 offset:53248
    s_add_u32 s99, s76, s101
    s_add_u32 m0, s80, 32768
    s_nop 0
    buffer_load_dwordx4 v5, s[40:43], s99 offen offset:0 lds
    v_mov_b32 v92, 150528
    ds_read_b32 v91, v92
    v_lshlrev_b32 v93, 2, v2
    v_add_u32 v93, 150016, v93
    ds_read2_b32 v[84:85], v93 offset0:0 offset1:32
    v_mfma_f32_32x32x16_bf16 v[160:175], a[168:171], v[112:115], v[160:175]
    buffer_load_dwordx4 v6, s[40:43], s99 offen offset:1024 lds
    ds_read2_b32 v[86:87], v93 offset0:64 offset1:96
    s_waitcnt lgkmcnt(2)
    v_readfirstlane_b32 s85, v91
    v_mov_b32 v73, v91
    v_mov_b32 v75, v91
    v_mov_b32 v77, v91
    v_mfma_f32_32x32x16_bf16 v[144:159], a[40:43], v[116:119], v[144:159]
    buffer_load_dwordx4 v7, s[40:43], s99 offen offset:2048 lds
    v_mov_b32 v79, v91
    s_lshl_b32 s92, s3, 11
    s_lshl_b32 s93, s4, 7
    s_add_u32 s92, s92, s93
    s_lshl_b32 s93, s5, 5
    v_mfma_f32_32x32x16_bf16 v[176:191], a[168:171], v[116:119], v[176:191]
    buffer_load_dwordx4 v8, s[40:43], s99 offen offset:3072 lds
    s_add_u32 s92, s92, s93
    s_mov_b32 exec_lo, 0
    s_mov_b32 exec_hi, 0x80000000
    buffer_store_dwordx4 v[72:75], off, s[60:63], s92 sc1
    buffer_store_dwordx4 v[76:79], off, s[60:63], s92 offset:16 sc1
    s_mov_b64 exec, -1
    ds_read_b128 a[52:55], v20 offset:49152
    ds_read_b128 a[180:183], v20 offset:53248
    ds_read_b128 v[104:107], v24 offset:49152
    ds_read_b128 v[108:111], v24 offset:53248
    v_mfma_f32_32x32x16_bf16 v[128:143], a[44:47], v[120:123], v[128:143]
    s_mul_i32 s99, s101, s78
    s_add_u32 s99, s99, s77
    s_add_u32 m0, s80, 98304
    s_nop 0
    buffer_load_dwordx4 v13, s[44:47], s99 offen offset:0 lds
    s_waitcnt lgkmcnt(5)
    v_add_f32 v84, v84, v85
    s_waitcnt lgkmcnt(4)
    v_add_f32 v86, v86, v87
    v_add_f32 v84, v84, v86
    v_mov_b32 v85, v91
    v_mfma_f32_32x32x16_bf16 v[160:175], a[172:175], v[120:123], v[160:175]
    buffer_load_dwordx4 v14, s[44:47], s99 offen offset:1024 lds
    s_lshl_b32 s92, s4, 3
    s_lshr_b32 s93, s3, 1
    s_add_u32 s92, s92, s93
    s_lshl_b32 s92, s92, 9
    s_and_b32 s93, s3, 1
    v_mfma_f32_32x32x16_bf16 v[144:159], a[44:47], v[124:127], v[144:159]
    buffer_load_dwordx4 v15, s[44:47], s99 offen offset:2048 lds
    s_lshl_b32 s93, s93, 3
    s_add_u32 s92, s92, s93
    s_add_u32 s92, s92, 196608
    v_lshlrev_b32 v93, 4, v2
    s_cmp_eq_u32 s5, 0
    s_cselect_b32 exec_lo, -1, 0
    s_mov_b32 exec_hi, 0
    buffer_store_dwordx2 v[84:85], v93, s[60:63], s92 offen sc1
    s_mov_b64 exec, -1
    v_mfma_f32_32x32x16_bf16 v[176:191], a[172:175], v[124:127], v[176:191]
    buffer_load_dwordx4 v16, s[44:47], s99 offen offset:3072 lds
    s_add_u32 s101, s101, 128
    s_and_b32 s101, s101, 1023
    v_mov_b32 v84, 0
    ds_read_b128 a[56:59], v21 offset:49152
    ds_read_b128 a[184:187], v21 offset:53248
    ds_read_b128 v[112:115], v25 offset:49152
    ds_read_b128 v[116:119], v25 offset:53248
    v_mfma_f32_32x32x16_bf16 v[128:143], a[48:51], v[96:99], v[128:143]
    v_mov_b32 v85, v91
    v_mov_b32 v86, 0
    v_mov_b32 v87, v91
    s_lshl_b32 s92, s2, 9
    s_add_u32 s92, s92, 262144
    v_mfma_f32_32x32x16_bf16 v[160:175], a[176:179], v[96:99], v[160:175]
    buffer_store_dwordx4 v[84:87], v93, s[60:63], s92 offen sc1
    s_lshl_b32 s68, s3, 11
    s_lshl_b32 s69, s6, 10
    s_add_u32 s68, s68, s69
    v_lshlrev_b32 v64, 4, v4
    v_mfma_f32_32x32x16_bf16 v[144:159], a[48:51], v[100:103], v[144:159]
    s_lshl_b32 s69, s4, 12
    s_add_u32 s69, s69, 196608
    v_lshlrev_b32 v65, 4, v2
    v_mfma_f32_32x32x16_bf16 v[176:191], a[176:179], v[100:103], v[176:191]
    ds_read_b128 a[60:63], v22 offset:49152
    ds_read_b128 a[188:191], v22 offset:53248
    ds_read_b128 v[120:123], v26 offset:49152
    ds_read_b128 v[124:127], v26 offset:53248
    s_waitcnt lgkmcnt(9)
    v_mfma_f32_32x32x16_bf16 v[128:143], a[52:55], v[104:107], v[128:143]
    v_mfma_f32_32x32x16_bf16 v[160:175], a[180:183], v[104:107], v[160:175]
    s_waitcnt lgkmcnt(8)
    v_mfma_f32_32x32x16_bf16 v[144:159], a[52:55], v[108:111], v[144:159]
    v_mfma_f32_32x32x16_bf16 v[176:191], a[180:183], v[108:111], v[176:191]
    s_waitcnt lgkmcnt(0)
    v_mfma_f32_32x32x16_bf16 v[128:143], a[56:59], v[112:115], v[128:143]
    s_waitcnt vmcnt(20)
    s_barrier
    ds_read_b128 a[64:67], v19 offset:0
    ds_read_b128 a[192:195], v19 offset:4096
    ds_read_b128 v[96:99], v23 offset:0
    ds_read_b128 v[100:103], v23 offset:4096
    s_add_u32 s99, s76, s101
    s_add_u32 m0, s80, 49152
    s_nop 0
    buffer_load_dwordx4 v5, s[40:43], s99 offen offset:0 lds
    v_mfma_f32_32x32x16_bf16 v[160:175], a[184:187], v[112:115], v[160:175]
    buffer_load_dwordx4 v6, s[40:43], s99 offen offset:1024 lds
    v_mfma_f32_32x32x16_bf16 v[144:159], a[56:59], v[116:119], v[144:159]
    buffer_load_dwordx4 v7, s[40:43], s99 offen offset:2048 lds
    v_mfma_f32_32x32x16_bf16 v[176:191], a[184:187], v[116:119], v[176:191]
    buffer_load_dwordx4 v8, s[40:43], s99 offen offset:3072 lds
    ds_read_b128 a[68:71], v20 offset:0
    ds_read_b128 a[196:199], v20 offset:4096
    ds_read_b128 v[104:107], v24 offset:0
    ds_read_b128 v[108:111], v24 offset:4096
    v_mfma_f32_32x32x16_bf16 v[128:143], a[60:63], v[120:123], v[128:143]
    s_mul_i32 s99, s101, s78
    s_add_u32 s99, s99, s77
    s_add_u32 m0, s80, 114688
    s_nop 0
    buffer_load_dwordx4 v13, s[44:47], s99 offen offset:0 lds
    v_mfma_f32_32x32x16_bf16 v[160:175], a[188:191], v[120:123], v[160:175]
    buffer_load_dwordx4 v14, s[44:47], s99 offen offset:1024 lds
    v_mfma_f32_32x32x16_bf16 v[144:159], a[60:63], v[124:127], v[144:159]
    buffer_load_dwordx4 v15, s[44:47], s99 offen offset:2048 lds
    v_mfma_f32_32x32x16_bf16 v[176:191], a[188:191], v[124:127], v[176:191]
    buffer_load_dwordx4 v16, s[44:47], s99 offen offset:3072 lds
    s_add_u32 s101, s101, 128
    s_and_b32 s101, s101, 1023
    ds_read_b128 a[72:75], v21 offset:0
    ds_read_b128 a[200:203], v21 offset:4096
    ds_read_b128 v[112:115], v25 offset:0
    ds_read_b128 v[116:119], v25 offset:4096
    s_waitcnt lgkmcnt(9)
    v_mfma_f32_32x32x16_bf16 v[128:143], a[64:67], v[96:99], v[128:143]
    v_mfma_f32_32x32x16_bf16 v[160:175], a[192:195], v[96:99], v[160:175]
    s_waitcnt lgkmcnt(8)
    v_mfma_f32_32x32x16_bf16 v[144:159], a[64:67], v[100:103], v[144:159]
    v_mfma_f32_32x32x16_bf16 v[176:191], a[192:195], v[100:103], v[176:191]
    ds_read_b128 a[76:79], v22 offset:0
    ds_read_b128 a[204:207], v22 offset:4096
    ds_read_b128 v[120:123], v26 offset:0
    ds_read_b128 v[124:127], v26 offset:4096
    s_waitcnt lgkmcnt(9)
    v_mfma_f32_32x32x16_bf16 v[128:143], a[68:71], v[104:107], v[128:143]
    v_mfma_f32_32x32x16_bf16 v[160:175], a[196:199], v[104:107], v[160:175]
    s_waitcnt lgkmcnt(8)
    v_mfma_f32_32x32x16_bf16 v[144:159], a[68:71], v[108:111], v[144:159]
    v_mfma_f32_32x32x16_bf16 v[176:191], a[196:199], v[108:111], v[176:191]
    s_waitcnt lgkmcnt(0)
    v_mfma_f32_32x32x16_bf16 v[128:143], a[72:75], v[112:115], v[128:143]
    s_waitcnt vmcnt(20)
    s_barrier
    ds_read_b128 a[80:83], v19 offset:16384
    ds_read_b128 a[208:211], v19 offset:20480
    ds_read_b128 v[96:99], v23 offset:16384
    ds_read_b128 v[100:103], v23 offset:20480
    s_mul_i32 s99, s100, 1376
    s_add_u32 s99, s99, s79
    s_add_u32 m0, s80, 0
    s_nop 0
    buffer_load_dwordx4 v9, s[48:51], s99 offen offset:0 lds
    buffer_load_dwordx4 v[208:211], v64, s[60:63], s68 offen sc1
    buffer_load_dwordx4 v[212:215], v64, s[60:63], s68 offen offset:512 sc1
    buffer_load_dwordx4 v[192:195], v65, s[60:63], s69 offen offset:0 sc1
    buffer_load_dwordx4 v[196:199], v65, s[60:63], s69 offen offset:512 sc1
    buffer_load_dwordx4 v[200:203], v65, s[60:63], s69 offen offset:2048 sc1
    v_mfma_f32_32x32x16_bf16 v[160:175], a[200:203], v[112:115], v[160:175]
    buffer_load_dwordx4 v[204:207], v65, s[60:63], s69 offen offset:2560 sc1
    v_mfma_f32_32x32x16_bf16 v[144:159], a[72:75], v[116:119], v[144:159]
    v_mfma_f32_32x32x16_bf16 v[176:191], a[200:203], v[116:119], v[176:191]
    buffer_load_dwordx4 v10, s[48:51], s99 offen offset:1024 lds
    ds_read_b128 a[84:87], v20 offset:16384
    ds_read_b128 a[212:215], v20 offset:20480
    ds_read_b128 v[104:107], v24 offset:16384
    ds_read_b128 v[108:111], v24 offset:20480
    v_mfma_f32_32x32x16_bf16 v[128:143], a[76:79], v[120:123], v[128:143]
    v_mfma_f32_32x32x16_bf16 v[160:175], a[204:207], v[120:123], v[160:175]
    v_mfma_f32_32x32x16_bf16 v[144:159], a[76:79], v[124:127], v[144:159]
    buffer_load_dwordx4 v11, s[48:51], s99 offen offset:2048 lds
    v_mfma_f32_32x32x16_bf16 v[176:191], a[204:207], v[124:127], v[176:191]
    ds_read_b128 a[88:91], v21 offset:16384
    ds_read_b128 a[216:219], v21 offset:20480
    ds_read_b128 v[112:115], v25 offset:16384
    ds_read_b128 v[116:119], v25 offset:20480
    s_waitcnt lgkmcnt(9)
    v_mfma_f32_32x32x16_bf16 v[128:143], a[80:83], v[96:99], v[128:143]
    v_mfma_f32_32x32x16_bf16 v[160:175], a[208:211], v[96:99], v[160:175]
    buffer_load_dwordx4 v12, s[48:51], s99 offen offset:3072 lds
    s_add_u32 s100, s100, 128
    s_and_b32 s100, s100, 1023
    s_waitcnt lgkmcnt(8)
    v_mfma_f32_32x32x16_bf16 v[144:159], a[80:83], v[100:103], v[144:159]
    v_mfma_f32_32x32x16_bf16 v[176:191], a[208:211], v[100:103], v[176:191]
    ds_read_b128 a[92:95], v22 offset:16384
    ds_read_b128 a[220:223], v22 offset:20480
    ds_read_b128 v[120:123], v26 offset:16384
    ds_read_b128 v[124:127], v26 offset:20480
    s_waitcnt lgkmcnt(9)
    v_mfma_f32_32x32x16_bf16 v[128:143], a[84:87], v[104:107], v[128:143]
    v_mfma_f32_32x32x16_bf16 v[160:175], a[212:215], v[104:107], v[160:175]
    s_waitcnt lgkmcnt(8)
    v_mfma_f32_32x32x16_bf16 v[144:159], a[84:87], v[108:111], v[144:159]
    v_mfma_f32_32x32x16_bf16 v[176:191], a[212:215], v[108:111], v[176:191]
    s_waitcnt lgkmcnt(0)
    v_mfma_f32_32x32x16_bf16 v[128:143], a[88:91], v[112:115], v[128:143]
    s_waitcnt vmcnt(19)
    s_barrier
    ds_read_b128 a[96:99], v19 offset:32768
    ds_read_b128 a[224:227], v19 offset:36864
    ds_read_b128 v[96:99], v23 offset:32768
    ds_read_b128 v[100:103], v23 offset:36864
    s_mul_i32 s99, s100, 1376
    s_add_u32 s99, s99, s79
    s_add_u32 m0, s80, 65536
    s_nop 0
    buffer_load_dwordx4 v9, s[48:51], s99 offen offset:0 lds
    v_mfma_f32_32x32x16_bf16 v[160:175], a[216:219], v[112:115], v[160:175]
    v_mfma_f32_32x32x16_bf16 v[144:159], a[88:91], v[116:119], v[144:159]
    v_mfma_f32_32x32x16_bf16 v[176:191], a[216:219], v[116:119], v[176:191]
    buffer_load_dwordx4 v10, s[48:51], s99 offen offset:1024 lds
    ds_read_b128 a[100:103], v20 offset:32768
    ds_read_b128 a[228:231], v20 offset:36864
    ds_read_b128 v[104:107], v24 offset:32768
    ds_read_b128 v[108:111], v24 offset:36864
    v_mfma_f32_32x32x16_bf16 v[128:143], a[92:95], v[120:123], v[128:143]
    v_mfma_f32_32x32x16_bf16 v[160:175], a[220:223], v[120:123], v[160:175]
    v_mfma_f32_32x32x16_bf16 v[144:159], a[92:95], v[124:127], v[144:159]
    buffer_load_dwordx4 v11, s[48:51], s99 offen offset:2048 lds
    v_mfma_f32_32x32x16_bf16 v[176:191], a[220:223], v[124:127], v[176:191]
    ds_read_b128 a[104:107], v21 offset:32768
    ds_read_b128 a[232:235], v21 offset:36864
    ds_read_b128 v[112:115], v25 offset:32768
    ds_read_b128 v[116:119], v25 offset:36864
    s_waitcnt lgkmcnt(9)
    v_mfma_f32_32x32x16_bf16 v[128:143], a[96:99], v[96:99], v[128:143]
    v_mfma_f32_32x32x16_bf16 v[160:175], a[224:227], v[96:99], v[160:175]
    buffer_load_dwordx4 v12, s[48:51], s99 offen offset:3072 lds
    s_add_u32 s100, s100, 128
    s_and_b32 s100, s100, 1023
    s_waitcnt lgkmcnt(8)
    v_mfma_f32_32x32x16_bf16 v[144:159], a[96:99], v[100:103], v[144:159]
    v_mfma_f32_32x32x16_bf16 v[176:191], a[224:227], v[100:103], v[176:191]
    ds_read_b128 a[108:111], v22 offset:32768
    ds_read_b128 a[236:239], v22 offset:36864
    ds_read_b128 v[120:123], v26 offset:32768
    ds_read_b128 v[124:127], v26 offset:36864
    s_waitcnt lgkmcnt(9)
    v_mfma_f32_32x32x16_bf16 v[128:143], a[100:103], v[104:107], v[128:143]
    v_mfma_f32_32x32x16_bf16 v[160:175], a[228:231], v[104:107], v[160:175]
    s_waitcnt lgkmcnt(8)
    v_mfma_f32_32x32x16_bf16 v[144:159], a[100:103], v[108:111], v[144:159]
    v_mfma_f32_32x32x16_bf16 v[176:191], a[228:231], v[108:111], v[176:191]
    s_waitcnt lgkmcnt(0)
    v_mfma_f32_32x32x16_bf16 v[128:143], a[104:107], v[112:115], v[128:143]
    s_waitcnt vmcnt(14)
    s_barrier
    ds_read_b128 a[112:115], v19 offset:49152
    ds_read_b128 a[240:243], v19 offset:53248
    ds_read_b128 v[96:99], v23 offset:49152
    ds_read_b128 v[100:103], v23 offset:53248
    s_mul_i32 s99, s100, 1376
    s_add_u32 s99, s99, s79
    s_add_u32 m0, s80, 16384
    s_nop 0
    buffer_load_dwordx4 v9, s[48:51], s99 offen offset:0 lds
    v_mfma_f32_32x32x16_bf16 v[160:175], a[232:235], v[112:115], v[160:175]
    v_mfma_f32_32x32x16_bf16 v[144:159], a[104:107], v[116:119], v[144:159]
    v_mfma_f32_32x32x16_bf16 v[176:191], a[232:235], v[116:119], v[176:191]
    buffer_load_dwordx4 v10, s[48:51], s99 offen offset:1024 lds
    ds_read_b128 a[116:119], v20 offset:49152
    ds_read_b128 a[244:247], v20 offset:53248
    ds_read_b128 v[104:107], v24 offset:49152
    ds_read_b128 v[108:111], v24 offset:53248
    v_mfma_f32_32x32x16_bf16 v[128:143], a[108:111], v[120:123], v[128:143]
    v_mfma_f32_32x32x16_bf16 v[160:175], a[236:239], v[120:123], v[160:175]
    v_mfma_f32_32x32x16_bf16 v[144:159], a[108:111], v[124:127], v[144:159]
    buffer_load_dwordx4 v11, s[48:51], s99 offen offset:2048 lds
    v_mfma_f32_32x32x16_bf16 v[176:191], a[236:239], v[124:127], v[176:191]
    ds_read_b128 a[120:123], v21 offset:49152
    ds_read_b128 a[248:251], v21 offset:53248
    ds_read_b128 v[112:115], v25 offset:49152
    ds_read_b128 v[116:119], v25 offset:53248
    s_waitcnt lgkmcnt(9)
    v_mfma_f32_32x32x16_bf16 v[128:143], a[112:115], v[96:99], v[128:143]
    v_mfma_f32_32x32x16_bf16 v[160:175], a[240:243], v[96:99], v[160:175]
    buffer_load_dwordx4 v12, s[48:51], s99 offen offset:3072 lds
    s_add_u32 s100, s100, 128
    s_and_b32 s100, s100, 1023
    s_waitcnt lgkmcnt(8)
    v_mfma_f32_32x32x16_bf16 v[144:159], a[112:115], v[100:103], v[144:159]
    v_mfma_f32_32x32x16_bf16 v[176:191], a[240:243], v[100:103], v[176:191]
    ds_read_b128 a[124:127], v22 offset:49152
    ds_read_b128 a[252:255], v22 offset:53248
    ds_read_b128 v[120:123], v26 offset:49152
    ds_read_b128 v[124:127], v26 offset:53248
    s_waitcnt lgkmcnt(9)
    v_mfma_f32_32x32x16_bf16 v[128:143], a[116:119], v[104:107], v[128:143]
    v_mfma_f32_32x32x16_bf16 v[160:175], a[244:247], v[104:107], v[160:175]
    s_waitcnt lgkmcnt(8)
    v_mfma_f32_32x32x16_bf16 v[144:159], a[116:119], v[108:111], v[144:159]
    v_mfma_f32_32x32x16_bf16 v[176:191], a[244:247], v[108:111], v[176:191]
    s_waitcnt lgkmcnt(0)
    v_mfma_f32_32x32x16_bf16 v[128:143], a[120:123], v[112:115], v[128:143]
    s_waitcnt vmcnt(11)
    v_mov_b32 v66, 0
    v_bitop3_b32 v66, v66, v193, s85 bitop3:0xf6
    v_bitop3_b32 v66, v66, v195, s85 bitop3:0xf6
    v_bitop3_b32 v66, v66, v197, s85 bitop3:0xf6
    v_bitop3_b32 v66, v66, v199, s85 bitop3:0xf6
    v_bitop3_b32 v66, v66, v201, s85 bitop3:0xf6
    v_bitop3_b32 v66, v66, v203, s85 bitop3:0xf6
    v_bitop3_b32 v66, v66, v205, s85 bitop3:0xf6
    v_bitop3_b32 v66, v66, v207, s85 bitop3:0xf6
    v_bitop3_b32 v66, v66, v209, s85 bitop3:0xf6
    v_bitop3_b32 v66, v66, v211, s85 bitop3:0xf6
    v_bitop3_b32 v66, v66, v213, s85 bitop3:0xf6
    v_bitop3_b32 v66, v66, v215, s85 bitop3:0xf6
    v_cmp_ne_u32 vcc, 0, v66
    s_cbranch_vccnz L_p1_ln0_slow
L_p1_ln0_ok:
    s_waitcnt vmcnt(8)
    s_barrier
    ds_read_b64_tr_b16 v[96:97], v34 offset:0
    ds_read_b64_tr_b16 v[98:99], v34 offset:512
    ds_read_b64_tr_b16 v[100:101], v34 offset:8192
    ds_read_b64_tr_b16 v[102:103], v34 offset:8704
    s_mul_i32 s99, s100, 1376
    s_add_u32 s99, s99, s79
    s_add_u32 m0, s80, 81920
    s_nop 0
    buffer_load_dwordx4 v9, s[48:51], s99 offen offset:0 lds
    v_mul_f32 v70, v210, v210
    v_mul_f32 v28, 0xc0135761, v210
    v_mul_f32 v71, v70, v210
    v_rcp_f32 v32, v70
    v_mul_f32 v30, 0xbdd2d3e8, v71
    v_mfma_f32_32x32x16_bf16 v[160:175], a[248:251], v[112:115], v[160:175]
    v_xor_b32 v70, 0x80000000, v208
    v_cndmask_b32 v70, v70, 0, s[88:89]
    v_lshrrev_b32 v37, 16, v70
    v_and_or_b32 v36, v70, s86, v37
    s_lshl_b32 s84, s6, 8
    v_mfma_f32_32x32x16_bf16 v[144:159], a[120:123], v[116:119], v[144:159]
    v_lshlrev_b32 v70, 2, v4
    v_add_u32 v70, s84, v70
    v_add_u32 v70, 147456, v70
    ds_write_b32 v70, v210
    v_mul_f32 v70, v214, v214
    v_mfma_f32_32x32x16_bf16 v[176:191], a[248:251], v[116:119], v[176:191]
    buffer_load_dwordx4 v10, s[48:51], s99 offen offset:1024 lds
    v_mul_f32 v29, 0xc0135761, v214
    v_mul_f32 v71, v70, v214
    v_rcp_f32 v33, v70
    v_mul_f32 v31, 0xbdd2d3e8, v71
    v_xor_b32 v70, 0x80000000, v212
    ds_read_b64_tr_b16 v[104:105], v34 offset:2048
    ds_read_b64_tr_b16 v[106:107], v34 offset:2560
    ds_read_b64_tr_b16 v[108:109], v34 offset:10240
    ds_read_b64_tr_b16 v[110:111], v34 offset:10752
    v_mfma_f32_32x32x16_bf16 v[128:143], a[124:127], v[120:123], v[128:143]
    v_cndmask_b32 v70, v70, 0, s[88:89]
    v_lshrrev_b32 v41, 16, v70
    v_and_or_b32 v40, v70, s86, v41
    s_lshl_b32 s84, s6, 8
    v_lshlrev_b32 v70, 2, v4
    v_mfma_f32_32x32x16_bf16 v[160:175], a[252:255], v[120:123], v[160:175]
    v_add_u32 v70, s84, v70
    v_add_u32 v70, 147584, v70
    ds_write_b32 v70, v214
    v_add_f32 v192, v192, v194
    v_and_b32 v193, s86, v192
    v_mfma_f32_32x32x16_bf16 v[144:159], a[124:127], v[124:127], v[144:159]
    buffer_load_dwordx4 v11, s[48:51], s99 offen offset:2048 lds
    v_sub_f32 v194, v192, v193
    v_and_b32 v195, s86, v194
    v_sub_f32 v194, v194, v195
    v_lshrrev_b32 v193, 16, v193
    v_or_b32 v44, v193, v195
    v_mfma_f32_32x32x16_bf16 v[176:191], a[252:255], v[124:127], v[176:191]
    v_lshrrev_b32 v45, 16, v194
    v_add_f32 v196, v196, v198
    v_and_b32 v197, s86, v196
    v_sub_f32 v198, v196, v197
    v_and_b32 v199, s86, v198
    v_sub_f32 v198, v198, v199
    v_lshrrev_b32 v197, 16, v197
    v_or_b32 v48, v197, v199
    v_lshrrev_b32 v49, 16, v198
    v_add_f32 v200, v200, v202
    v_and_b32 v201, s86, v200
    v_sub_f32 v202, v200, v201
    v_and_b32 v203, s86, v202
    v_sub_f32 v202, v202, v203
    v_lshrrev_b32 v201, 16, v201
    v_or_b32 v0, v201, v203
    v_lshrrev_b32 v16, 16, v202
    v_add_f32 v204, v204, v206
    v_and_b32 v205, s86, v204
    v_sub_f32 v206, v204, v205
    v_and_b32 v207, s86, v206
    v_sub_f32 v206, v206, v207
    v_lshrrev_b32 v205, 16, v205
    v_or_b32 v18, v205, v207
    v_lshrrev_b32 v5, 16, v206
    v_sub_f32 v13, 0, v53
    v_sub_f32 v14, 0, v55
    v_sub_f32 v15, 0, v59
    v_mfma_f32_32x32x16_bf16 v[128:143], v[36:39], v[44:47], v[128:143]
    v_mfma_f32_32x32x16_bf16 v[160:175], v[40:43], v[44:47], v[160:175]
    v_mfma_f32_32x32x16_bf16 v[144:159], v[36:39], v[48:51], v[144:159]
    v_mfma_f32_32x32x16_bf16 v[176:191], v[40:43], v[48:51], v[176:191]
    ds_read_b64_tr_b16 v[112:113], v34 offset:4096
    ds_read_b64_tr_b16 v[114:115], v34 offset:4608
    ds_read_b64_tr_b16 v[116:117], v34 offset:12288
    ds_read_b64_tr_b16 v[118:119], v34 offset:12800
    s_waitcnt lgkmcnt(12)
    v_mfma_f32_32x32x16_bf16 v[192:207], v[96:99], a[0:3], 0
    s_lshl_b32 s83, s6, 8
    v_lshlrev_b32 v7, 6, v3
    v_add_u32 v7, s83, v7
    v_add_u32 v7, 147456, v7
    ds_read_b128 v[44:47], v7 offset:0
    ds_read_b128 v[48:51], v7 offset:16
    v_mfma_f32_32x32x16_bf16 v[224:239], v[96:99], a[128:131], 0
    buffer_load_dwordx4 v12, s[48:51], s99 offen offset:3072 lds
    s_add_u32 s100, s100, 128
    s_and_b32 s100, s100, 1023
    s_waitcnt lgkmcnt(1)
    v_mul_f32 v128, v44, v128
    v_mul_f32 v144, v44, v144
    v_mul_f32 v64, v58, v128
    v_mul_f32 v65, v58, v144
    v_fmac_f32 v64, v15, v144
    v_fmac_f32 v65, v59, v128
    v_mfma_f32_32x32x16_bf16 v[208:223], v[100:103], a[0:3], 0
    v_mul_f32 v129, v45, v129
    v_mul_f32 v145, v45, v145
    v_mul_f32 v66, v58, v129
    v_mul_f32 v67, v58, v145
    v_fmac_f32 v66, v15, v145
    v_fmac_f32 v67, v59, v129
    v_mfma_f32_32x32x16_bf16 v[240:255], v[100:103], a[128:131], 0
    v_fma_f32 v20, v52, v64, v66
    v_fma_f32 v21, v52, v65, v67
    v_fmac_f32 v20, v13, v65
    v_fmac_f32 v21, v53, v64
    v_mul_f32 v130, v46, v130
    v_mul_f32 v146, v46, v146
    ds_read_b64_tr_b16 v[120:121], v34 offset:6144
    ds_read_b64_tr_b16 v[122:123], v34 offset:6656
    ds_read_b64_tr_b16 v[124:125], v34 offset:14336
    ds_read_b64_tr_b16 v[126:127], v34 offset:14848
    v_mfma_f32_32x32x16_bf16 v[192:207], v[104:107], a[4:7], v[192:207]
    v_mul_f32 v68, v58, v130
    v_mul_f32 v69, v58, v146
    v_fmac_f32 v68, v15, v146
    v_fmac_f32 v69, v59, v130
    v_fma_f32 v8, v52, v20, v68
    v_fma_f32 v19, v52, v21, v69
    v_mfma_f32_32x32x16_bf16 v[224:239], v[104:107], a[132:135], v[224:239]
    v_fmac_f32 v8, v13, v21
    v_fmac_f32 v19, v53, v20
    v_mul_f32 v131, v47, v131
    v_mul_f32 v147, v47, v147
    v_mul_f32 v70, v58, v131
    v_mul_f32 v71, v58, v147
    v_mfma_f32_32x32x16_bf16 v[208:223], v[108:111], a[4:7], v[208:223]
    v_fmac_f32 v70, v15, v147
    v_fmac_f32 v71, v59, v131
    v_fma_f32 v20, v52, v8, v70
    v_fma_f32 v21, v52, v19, v71
    v_fmac_f32 v20, v13, v19
    v_fmac_f32 v21, v53, v8
    v_mfma_f32_32x32x16_bf16 v[240:255], v[108:111], a[132:135], v[240:255]
    ds_read_b128 v[44:47], v7 offset:32
    s_waitcnt lgkmcnt(5)
    v_mul_f32 v132, v48, v132
    v_mul_f32 v148, v48, v148
    v_mul_f32 v72, v58, v132
    v_mul_f32 v73, v58, v148
    v_fmac_f32 v72, v15, v148
    s_waitcnt lgkmcnt(0)
    v_mfma_f32_32x32x16_bf16 v[192:207], v[112:115], a[8:11], v[192:207]
    s_waitcnt vmcnt(8)
    s_barrier
    ds_read_b64_tr_b16 v[96:97], v35 offset:0
    ds_read_b64_tr_b16 v[98:99], v35 offset:512
    ds_read_b64_tr_b16 v[100:101], v35 offset:8192
    ds_read_b64_tr_b16 v[102:103], v35 offset:8704
    s_mul_i32 s99, s100, 1376
    s_add_u32 s99, s99, s79
    s_add_u32 m0, s80, 32768
    s_nop 0
    buffer_load_dwordx4 v9, s[48:51], s99 offen offset:0 lds
    v_fmac_f32 v73, v59, v132
    v_fma_f32 v8, v52, v20, v72
    v_fma_f32 v19, v52, v21, v73
    v_fmac_f32 v8, v13, v21
    v_fmac_f32 v19, v53, v20
    v_mul_f32 v133, v49, v133
    v_mfma_f32_32x32x16_bf16 v[224:239], v[112:115], a[136:139], v[224:239]
    v_mul_f32 v149, v49, v149
    v_mul_f32 v74, v58, v133
    v_mul_f32 v75, v58, v149
    v_fmac_f32 v74, v15, v149
    v_fmac_f32 v75, v59, v133
    v_fma_f32 v20, v52, v8, v74
    v_mfma_f32_32x32x16_bf16 v[208:223], v[116:119], a[8:11], v[208:223]
    v_fma_f32 v21, v52, v19, v75
    v_fmac_f32 v20, v13, v19
    v_fmac_f32 v21, v53, v8
    v_mul_f32 v134, v50, v134
    v_mul_f32 v150, v50, v150
    v_mul_f32 v76, v58, v134
    v_mfma_f32_32x32x16_bf16 v[240:255], v[116:119], a[136:139], v[240:255]
    buffer_load_dwordx4 v10, s[48:51], s99 offen offset:1024 lds
    v_mul_f32 v77, v58, v150
    v_fmac_f32 v76, v15, v150
    v_fmac_f32 v77, v59, v134
    v_fma_f32 v8, v52, v20, v76
    v_fma_f32 v19, v52, v21, v77
    v_fmac_f32 v8, v13, v21
    ds_read_b64_tr_b16 v[104:105], v35 offset:2048
    ds_read_b64_tr_b16 v[106:107], v35 offset:2560
    ds_read_b64_tr_b16 v[108:109], v35 offset:10240
    ds_read_b64_tr_b16 v[110:111], v35 offset:10752
    v_mfma_f32_32x32x16_bf16 v[192:207], v[120:123], a[12:15], v[192:207]
    v_fmac_f32 v19, v53, v20
    v_mul_f32 v135, v51, v135
    v_mul_f32 v151, v51, v151
    v_mul_f32 v78, v58, v135
    v_mul_f32 v79, v58, v151
    v_fmac_f32 v78, v15, v151
    v_mfma_f32_32x32x16_bf16 v[224:239], v[120:123], a[140:143], v[224:239]
    v_fmac_f32 v79, v59, v135
    v_fma_f32 v20, v52, v8, v78
    v_fma_f32 v21, v52, v19, v79
    v_fmac_f32 v20, v13, v19
    v_fmac_f32 v21, v53, v8
    ds_read_b128 v[48:51], v7 offset:48
    v_mfma_f32_32x32x16_bf16 v[208:223], v[124:127], a[12:15], v[208:223]
    buffer_load_dwordx4 v11, s[48:51], s99 offen offset:2048 lds
    v_mul_f32 v136, v44, v136
    v_mul_f32 v152, v44, v152
    v_mul_f32 v80, v58, v136
    v_mul_f32 v81, v58, v152
    v_fmac_f32 v80, v15, v152
    v_fmac_f32 v81, v59, v136
    v_mfma_f32_32x32x16_bf16 v[240:255], v[124:127], a[140:143], v[240:255]
    v_fma_f32 v8, v52, v20, v80
    v_fma_f32 v19, v52, v21, v81
    v_fmac_f32 v8, v13, v21
    v_fmac_f32 v19, v53, v20
    v_mul_f32 v137, v45, v137
    v_mul_f32 v153, v45, v153
    ds_read_b64_tr_b16 v[112:113], v35 offset:4096
    ds_read_b64_tr_b16 v[114:115], v35 offset:4608
    ds_read_b64_tr_b16 v[116:117], v35 offset:12288
    ds_read_b64_tr_b16 v[118:119], v35 offset:12800
    s_waitcnt lgkmcnt(11)
    v_mfma_f32_32x32x16_bf16 v[192:207], v[96:99], a[16:19], v[192:207]
    v_mul_f32 v82, v58, v137
    v_mul_f32 v83, v58, v153
    v_fmac_f32 v82, v15, v153
    v_fmac_f32 v83, v59, v137
    v_fma_f32 v20, v52, v8, v82
    v_fma_f32 v21, v52, v19, v83
    v_mfma_f32_32x32x16_bf16 v[224:239], v[96:99], a[144:147], v[224:239]
    buffer_load_dwordx4 v12, s[48:51], s99 offen offset:3072 lds
    s_add_u32 s100, s100, 128
    s_and_b32 s100, s100, 1023
    v_fmac_f32 v20, v13, v19
    v_fmac_f32 v21, v53, v8
    v_mul_f32 v138, v46, v138
    v_mul_f32 v154, v46, v154
    v_mul_f32 v84, v58, v138
    v_mul_f32 v85, v58, v154
    s_waitcnt lgkmcnt(9)
    v_mfma_f32_32x32x16_bf16 v[208:223], v[100:103], a[16:19], v[208:223]
    v_fmac_f32 v84, v15, v154
    v_fmac_f32 v85, v59, v138
    v_fma_f32 v8, v52, v20, v84
    v_fma_f32 v19, v52, v21, v85
    v_fmac_f32 v8, v13, v21
    v_fmac_f32 v19, v53, v20
    v_mfma_f32_32x32x16_bf16 v[240:255], v[100:103], a[144:147], v[240:255]
    v_mul_f32 v139, v47, v139
    v_mul_f32 v155, v47, v155
    v_mul_f32 v86, v58, v139
    v_mul_f32 v87, v58, v155
    v_fmac_f32 v86, v15, v155
    v_fmac_f32 v87, v59, v139
    ds_read_b64_tr_b16 v[120:121], v35 offset:6144
    ds_read_b64_tr_b16 v[122:123], v35 offset:6656
    ds_read_b64_tr_b16 v[124:125], v35 offset:14336
    ds_read_b64_tr_b16 v[126:127], v35 offset:14848
    s_waitcnt lgkmcnt(11)
    v_mfma_f32_32x32x16_bf16 v[192:207], v[104:107], a[20:23], v[192:207]
    v_fma_f32 v20, v52, v8, v86
    v_fma_f32 v21, v52, v19, v87
    v_fmac_f32 v20, v13, v19
    v_fmac_f32 v21, v53, v8
    ds_read_b128 v[44:47], v7 offset:128
    s_waitcnt lgkmcnt(9)
    v_mul_f32 v140, v48, v140
    v_mfma_f32_32x32x16_bf16 v[224:239], v[104:107], a[148:151], v[224:239]
    v_mul_f32 v156, v48, v156
    v_mul_f32 v88, v58, v140
    v_mul_f32 v89, v58, v156
    v_fmac_f32 v88, v15, v156
    v_fmac_f32 v89, v59, v140
    v_fma_f32 v8, v52, v20, v88
    v_mfma_f32_32x32x16_bf16 v[208:223], v[108:111], a[20:23], v[208:223]
    v_fma_f32 v19, v52, v21, v89
    v_fmac_f32 v8, v13, v21
    v_fmac_f32 v19, v53, v20
    v_mul_f32 v141, v49, v141
    v_mul_f32 v157, v49, v157
    v_mul_f32 v90, v58, v141
    v_mfma_f32_32x32x16_bf16 v[240:255], v[108:111], a[148:151], v[240:255]
    v_mul_f32 v91, v58, v157
    v_fmac_f32 v90, v15, v157
    v_fmac_f32 v91, v59, v141
    v_fma_f32 v20, v52, v8, v90
    v_fma_f32 v21, v52, v19, v91
    v_fmac_f32 v20, v13, v19
    s_waitcnt lgkmcnt(0)
    v_mfma_f32_32x32x16_bf16 v[192:207], v[112:115], a[24:27], v[192:207]
    s_waitcnt vmcnt(8)
    s_barrier
    ds_read_b64_tr_b16 v[96:97], v34 offset:16384
    ds_read_b64_tr_b16 v[98:99], v34 offset:16896
    ds_read_b64_tr_b16 v[100:101], v34 offset:24576
    ds_read_b64_tr_b16 v[102:103], v34 offset:25088
    s_mul_i32 s99, s100, 1376
    s_add_u32 s99, s99, s79
    s_add_u32 m0, s80, 98304
    s_nop 0
    buffer_load_dwordx4 v9, s[48:51], s99 offen offset:0 lds
    v_fmac_f32 v21, v53, v8
    v_mul_f32 v142, v50, v142
    v_mul_f32 v158, v50, v158
    v_mul_f32 v92, v58, v142
    v_mul_f32 v93, v58, v158
    v_fmac_f32 v92, v15, v158
    v_mfma_f32_32x32x16_bf16 v[224:239], v[112:115], a[152:155], v[224:239]
    v_fmac_f32 v93, v59, v142
    v_fma_f32 v8, v52, v20, v92
    v_fma_f32 v19, v52, v21, v93
    v_fmac_f32 v8, v13, v21
    v_fmac_f32 v19, v53, v20
    v_mul_f32 v143, v51, v143
    v_mfma_f32_32x32x16_bf16 v[208:223], v[116:119], a[24:27], v[208:223]
    v_mul_f32 v159, v51, v159
    v_mul_f32 v94, v58, v143
    v_mul_f32 v95, v58, v159
    v_fmac_f32 v94, v15, v159
    v_fmac_f32 v95, v59, v143
    v_fma_f32 v22, v52, v8, v94
    v_mfma_f32_32x32x16_bf16 v[240:255], v[116:119], a[152:155], v[240:255]
    buffer_load_dwordx4 v10, s[48:51], s99 offen offset:1024 lds
    v_fma_f32 v23, v52, v19, v95
    v_fmac_f32 v22, v13, v19
    v_fmac_f32 v23, v53, v8
    s_lshl_b32 s83, s6, 10
    v_lshlrev_b32 v8, 3, v2
    v_lshl_add_u32 v8, v3, 8, v8
    ds_read_b64_tr_b16 v[104:105], v34 offset:18432
    ds_read_b64_tr_b16 v[106:107], v34 offset:18944
    ds_read_b64_tr_b16 v[108:109], v34 offset:26624
    ds_read_b64_tr_b16 v[110:111], v34 offset:27136
    v_mfma_f32_32x32x16_bf16 v[192:207], v[120:123], a[28:31], v[192:207]
    v_add_u32 v8, s83, v8
    v_add_u32 v8, 147968, v8
    ds_write_b64 v8, v[22:23]
    ds_read_b128 v[48:51], v7 offset:144
    v_mul_f32 v160, v44, v160
    v_mul_f32 v176, v44, v176
    v_mfma_f32_32x32x16_bf16 v[224:239], v[120:123], a[156:159], v[224:239]
    v_mul_f32 v128, v58, v160
    v_mul_f32 v129, v58, v176
    v_fmac_f32 v128, v15, v176
    v_fmac_f32 v129, v59, v160
    v_mul_f32 v161, v45, v161
    v_mul_f32 v177, v45, v177
    v_mfma_f32_32x32x16_bf16 v[208:223], v[124:127], a[28:31], v[208:223]
    buffer_load_dwordx4 v11, s[48:51], s99 offen offset:2048 lds
    v_mul_f32 v130, v58, v161
    v_mul_f32 v131, v58, v177
    v_fmac_f32 v130, v15, v177
    v_fmac_f32 v131, v59, v161
    v_fma_f32 v20, v52, v128, v130
    v_fma_f32 v21, v52, v129, v131
    v_mfma_f32_32x32x16_bf16 v[240:255], v[124:127], a[156:159], v[240:255]
    v_fmac_f32 v20, v13, v129
    v_fmac_f32 v21, v53, v128
    v_mul_f32 v162, v46, v162
    v_mul_f32 v178, v46, v178
    v_mul_f32 v132, v58, v162
    v_mul_f32 v133, v58, v178
    ds_read_b64_tr_b16 v[112:113], v34 offset:20480
    ds_read_b64_tr_b16 v[114:115], v34 offset:20992
    ds_read_b64_tr_b16 v[116:117], v34 offset:28672
    ds_read_b64_tr_b16 v[118:119], v34 offset:29184
    s_waitcnt lgkmcnt(12)
    v_mfma_f32_32x32x16_bf16 v[192:207], v[96:99], a[32:35], v[192:207]
    v_fmac_f32 v132, v15, v178
    v_fmac_f32 v133, v59, v162
    v_fma_f32 v8, v52, v20, v132
    v_fma_f32 v19, v52, v21, v133
    v_fmac_f32 v8, v13, v21
    v_fmac_f32 v19, v53, v20
    v_mfma_f32_32x32x16_bf16 v[224:239], v[96:99], a[160:163], v[224:239]
    buffer_load_dwordx4 v12, s[48:51], s99 offen offset:3072 lds
    s_add_u32 s100, s100, 128
    s_and_b32 s100, s100, 1023
    v_mul_f32 v163, v47, v163
    v_mul_f32 v179, v47, v179
    v_mul_f32 v134, v58, v163
    v_mul_f32 v135, v58, v179
    v_fmac_f32 v134, v15, v179
    v_fmac_f32 v135, v59, v163
    s_waitcnt lgkmcnt(10)
    v_mfma_f32_32x32x16_bf16 v[208:223], v[100:103], a[32:35], v[208:223]
    v_fma_f32 v20, v52, v8, v134
    v_fma_f32 v21, v52, v19, v135
    v_fmac_f32 v20, v13, v19
    v_fmac_f32 v21, v53, v8
    ds_read_b128 v[44:47], v7 offset:160
    s_waitcnt lgkmcnt(5)
    v_mul_f32 v164, v48, v164
    v_mfma_f32_32x32x16_bf16 v[240:255], v[100:103], a[160:163], v[240:255]
    v_mul_f32 v180, v48, v180
    v_mul_f32 v136, v58, v164
    v_mul_f32 v137, v58, v180
    v_fmac_f32 v136, v15, v180
    v_fmac_f32 v137, v59, v164
    v_fma_f32 v8, v52, v20, v136
    ds_read_b64_tr_b16 v[120:121], v34 offset:22528
    ds_read_b64_tr_b16 v[122:123], v34 offset:23040
    ds_read_b64_tr_b16 v[124:125], v34 offset:30720
    ds_read_b64_tr_b16 v[126:127], v34 offset:31232
    v_mfma_f32_32x32x16_bf16 v[192:207], v[104:107], a[36:39], v[192:207]
    v_fma_f32 v19, v52, v21, v137
    v_fmac_f32 v8, v13, v21
    v_fmac_f32 v19, v53, v20
    v_mul_f32 v165, v49, v165
    v_mul_f32 v181, v49, v181
    v_mul_f32 v138, v58, v165
    v_mfma_f32_32x32x16_bf16 v[224:239], v[104:107], a[164:167], v[224:239]
    v_mul_f32 v139, v58, v181
    v_fmac_f32 v138, v15, v181
    v_fmac_f32 v139, v59, v165
    v_fma_f32 v20, v52, v8, v138
    v_fma_f32 v21, v52, v19, v139
    v_fmac_f32 v20, v13, v19
    v_mfma_f32_32x32x16_bf16 v[208:223], v[108:111], a[36:39], v[208:223]
    v_fmac_f32 v21, v53, v8
    v_mul_f32 v166, v50, v166
    v_mul_f32 v182, v50, v182
    v_mul_f32 v140, v58, v166
    v_mul_f32 v141, v58, v182
    v_fmac_f32 v140, v15, v182
    v_mfma_f32_32x32x16_bf16 v[240:255], v[108:111], a[164:167], v[240:255]
    v_fmac_f32 v141, v59, v166
    v_fma_f32 v8, v52, v20, v140
    v_fma_f32 v19, v52, v21, v141
    v_fmac_f32 v8, v13, v21
    v_fmac_f32 v19, v53, v20
    v_mul_f32 v167, v51, v167
    s_waitcnt lgkmcnt(0)
    v_mfma_f32_32x32x16_bf16 v[192:207], v[112:115], a[40:43], v[192:207]
    s_waitcnt vmcnt(8)
    s_barrier
    ds_read_b64_tr_b16 v[96:97], v35 offset:16384
    ds_read_b64_tr_b16 v[98:99], v35 offset:16896
    ds_read_b64_tr_b16 v[100:101], v35 offset:24576
    ds_read_b64_tr_b16 v[102:103], v35 offset:25088
    s_mul_i32 s99, s100, 1376
    s_add_u32 s99, s99, s79
    s_add_u32 m0, s80, 49152
    s_nop 0
    buffer_load_dwordx4 v9, s[48:51], s99 offen offset:0 lds
    v_mul_f32 v183, v51, v183
    v_mul_f32 v142, v58, v167
    v_mul_f32 v143, v58, v183
    v_fmac_f32 v142, v15, v183
    v_fmac_f32 v143, v59, v167
    v_fma_f32 v20, v52, v8, v142
    v_mfma_f32_32x32x16_bf16 v[224:239], v[112:115], a[168:171], v[224:239]
    v_fma_f32 v21, v52, v19, v143
    v_fmac_f32 v20, v13, v19
    v_fmac_f32 v21, v53, v8
    ds_read_b128 v[48:51], v7 offset:176
    v_mul_f32 v168, v44, v168
    v_mul_f32 v184, v44, v184
    v_mfma_f32_32x32x16_bf16 v[208:223], v[116:119], a[40:43], v[208:223]
    v_mul_f32 v144, v58, v168
    v_mul_f32 v145, v58, v184
    v_fmac_f32 v144, v15, v184
    v_fmac_f32 v145, v59, v168
    v_fma_f32 v8, v52, v20, v144
    v_fma_f32 v19, v52, v21, v145
    v_mfma_f32_32x32x16_bf16 v[240:255], v[116:119], a[168:171], v[240:255]
    buffer_load_dwordx4 v10, s[48:51], s99 offen offset:1024 lds
    v_fmac_f32 v8, v13, v21
    v_fmac_f32 v19, v53, v20
    v_mul_f32 v169, v45, v169
    v_mul_f32 v185, v45, v185
    v_mul_f32 v146, v58, v169
    v_mul_f32 v147, v58, v185
    ds_read_b64_tr_b16 v[104:105], v35 offset:18432
    ds_read_b64_tr_b16 v[106:107], v35 offset:18944
    ds_read_b64_tr_b16 v[108:109], v35 offset:26624
    ds_read_b64_tr_b16 v[110:111], v35 offset:27136
    v_mfma_f32_32x32x16_bf16 v[192:207], v[120:123], a[44:47], v[192:207]
    v_fmac_f32 v146, v15, v185
    v_fmac_f32 v147, v59, v169
    v_fma_f32 v20, v52, v8, v146
    v_fma_f32 v21, v52, v19, v147
    v_fmac_f32 v20, v13, v19
    v_fmac_f32 v21, v53, v8
    v_mfma_f32_32x32x16_bf16 v[224:239], v[120:123], a[172:175], v[224:239]
    v_mul_f32 v170, v46, v170
    v_mul_f32 v186, v46, v186
    v_mul_f32 v148, v58, v170
    v_mul_f32 v149, v58, v186
    v_fmac_f32 v148, v15, v186
    v_fmac_f32 v149, v59, v170
    v_mfma_f32_32x32x16_bf16 v[208:223], v[124:127], a[44:47], v[208:223]
    buffer_load_dwordx4 v11, s[48:51], s99 offen offset:2048 lds
    v_fma_f32 v8, v52, v20, v148
    v_fma_f32 v19, v52, v21, v149
    v_fmac_f32 v8, v13, v21
    v_fmac_f32 v19, v53, v20
    v_mul_f32 v171, v47, v171
    v_mul_f32 v187, v47, v187
    v_mfma_f32_32x32x16_bf16 v[240:255], v[124:127], a[172:175], v[240:255]
    v_mul_f32 v150, v58, v171
    v_mul_f32 v151, v58, v187
    v_fmac_f32 v150, v15, v187
    v_fmac_f32 v151, v59, v171
    v_fma_f32 v20, v52, v8, v150
    v_fma_f32 v21, v52, v19, v151
    ds_read_b64_tr_b16 v[112:113], v35 offset:20480
    ds_read_b64_tr_b16 v[114:115], v35 offset:20992
    ds_read_b64_tr_b16 v[116:117], v35 offset:28672
    ds_read_b64_tr_b16 v[118:119], v35 offset:29184
    s_waitcnt lgkmcnt(11)
    v_mfma_f32_32x32x16_bf16 v[192:207], v[96:99], a[48:51], v[192:207]
    v_fmac_f32 v20, v13, v19
    v_fmac_f32 v21, v53, v8
    s_waitcnt lgkmcnt(8)
    v_mul_f32 v172, v48, v172
    v_mul_f32 v188, v48, v188
    v_mul_f32 v152, v58, v172
    v_mul_f32 v153, v58, v188
    v_mfma_f32_32x32x16_bf16 v[224:239], v[96:99], a[176:179], v[224:239]
    buffer_load_dwordx4 v12, s[48:51], s99 offen offset:3072 lds
    s_add_u32 s100, s100, 128
    s_and_b32 s100, s100, 1023
    v_fmac_f32 v152, v15, v188
    v_fmac_f32 v153, v59, v172
    v_fma_f32 v8, v52, v20, v152
    v_fma_f32 v19, v52, v21, v153
    v_fmac_f32 v8, v13, v21
    v_fmac_f32 v19, v53, v20
    v_mfma_f32_32x32x16_bf16 v[208:223], v[100:103], a[48:51], v[208:223]
    v_mul_f32 v173, v49, v173
    v_mul_f32 v189, v49, v189
    v_mul_f32 v154, v58, v173
    v_mul_f32 v155, v58, v189
    v_fmac_f32 v154, v15, v189
    v_fmac_f32 v155, v59, v173
    v_mfma_f32_32x32x16_bf16 v[240:255], v[100:103], a[176:179], v[240:255]
    v_fma_f32 v20, v52, v8, v154
    v_fma_f32 v21, v52, v19, v155
    v_fmac_f32 v20, v13, v19
    v_fmac_f32 v21, v53, v8
    v_mul_f32 v174, v50, v174
    v_mul_f32 v190, v50, v190
    ds_read_b64_tr_b16 v[120:121], v35 offset:22528
    ds_read_b64_tr_b16 v[122:123], v35 offset:23040
    ds_read_b64_tr_b16 v[124:125], v35 offset:30720
    ds_read_b64_tr_b16 v[126:127], v35 offset:31232
    s_waitcnt lgkmcnt(10)
    v_mfma_f32_32x32x16_bf16 v[192:207], v[104:107], a[52:55], v[192:207]
    v_mul_f32 v156, v58, v174
    v_mul_f32 v157, v58, v190
    v_fmac_f32 v156, v15, v190
    v_fmac_f32 v157, v59, v174
    v_fma_f32 v8, v52, v20, v156
    v_fma_f32 v19, v52, v21, v157
    v_mfma_f32_32x32x16_bf16 v[224:239], v[104:107], a[180:183], v[224:239]
    v_fmac_f32 v8, v13, v21
    v_fmac_f32 v19, v53, v20
    v_mul_f32 v175, v51, v175
    v_mul_f32 v191, v51, v191
    v_mul_f32 v158, v58, v175
    v_mul_f32 v159, v58, v191
    s_waitcnt lgkmcnt(8)
    v_mfma_f32_32x32x16_bf16 v[208:223], v[108:111], a[52:55], v[208:223]
    v_fmac_f32 v158, v15, v191
    v_fmac_f32 v159, v59, v175
    v_fma_f32 v24, v52, v8, v158
    v_fma_f32 v25, v52, v19, v159
    v_fmac_f32 v24, v13, v19
    v_fmac_f32 v25, v53, v8
    v_mfma_f32_32x32x16_bf16 v[240:255], v[108:111], a[180:183], v[240:255]
    s_lshl_b32 s83, s6, 10
    v_lshlrev_b32 v8, 3, v2
    v_lshl_add_u32 v8, v3, 8, v8
    v_add_u32 v8, s83, v8
    v_add_u32 v8, 148480, v8
    ds_write_b64 v8, v[24:25]
    s_waitcnt lgkmcnt(0)
    v_mfma_f32_32x32x16_bf16 v[192:207], v[112:115], a[56:59], v[192:207]
    s_waitcnt vmcnt(8)
    s_barrier
    ds_read_b64_tr_b16 v[96:97], v34 offset:32768
    ds_read_b64_tr_b16 v[98:99], v34 offset:33280
    ds_read_b64_tr_b16 v[100:101], v34 offset:40960
    ds_read_b64_tr_b16 v[102:103], v34 offset:41472
    s_mul_i32 s99, s100, 1376
    s_add_u32 s99, s99, s79
    s_add_u32 m0, s80, 114688
    s_nop 0
    buffer_load_dwordx4 v9, s[48:51], s99 offen offset:0 lds
    v_lshlrev_b32 v7, 3, v2
    v_add_u32 v7, 147968, v7
    ds_read2_b64 v[160:163], v7 offset0:0 offset1:32
    ds_read2_b64 v[164:167], v7 offset0:64 offset1:96
    s_lshl_b32 s83, s6, 10
    v_add_u32 v7, s83, v7
    v_mfma_f32_32x32x16_bf16 v[224:239], v[112:115], a[184:187], v[224:239]
    ds_read2_b64 v[168:171], v7 offset0:0 offset1:32
    ds_read2_b64 v[172:175], v7 offset0:64 offset1:96
    s_waitcnt lgkmcnt(3)
    v_fmac_f32 v162, v54, v160
    v_fmac_f32 v163, v54, v161
    v_fmac_f32 v162, v14, v161
    v_fmac_f32 v163, v55, v160
    v_mfma_f32_32x32x16_bf16 v[208:223], v[116:119], a[56:59], v[208:223]
    s_waitcnt lgkmcnt(2)
    v_fmac_f32 v164, v54, v162
    v_fmac_f32 v165, v54, v163
    v_fmac_f32 v164, v14, v163
    v_fmac_f32 v165, v55, v162
    v_fmac_f32 v166, v54, v164
    v_fmac_f32 v167, v54, v165
    v_mfma_f32_32x32x16_bf16 v[240:255], v[116:119], a[184:187], v[240:255]
    buffer_load_dwordx4 v10, s[48:51], s99 offen offset:1024 lds
    v_fmac_f32 v166, v14, v165
    v_fmac_f32 v167, v55, v164
    v_mul_f32 v166, s87, v166
    v_mul_f32 v167, s87, v167
    s_waitcnt lgkmcnt(1)
    v_fmac_f32 v168, v54, v166
    v_fmac_f32 v169, v54, v167
    ds_read_b64_tr_b16 v[104:105], v34 offset:34816
    ds_read_b64_tr_b16 v[106:107], v34 offset:35328
    ds_read_b64_tr_b16 v[108:109], v34 offset:43008
    ds_read_b64_tr_b16 v[110:111], v34 offset:43520
    v_mfma_f32_32x32x16_bf16 v[192:207], v[120:123], a[60:63], v[192:207]
    v_fmac_f32 v168, v14, v167
    v_fmac_f32 v169, v55, v166
    v_fmac_f32 v170, v54, v168
    v_fmac_f32 v171, v54, v169
    v_fmac_f32 v170, v14, v169
    v_fmac_f32 v171, v55, v168
    v_mfma_f32_32x32x16_bf16 v[224:239], v[120:123], a[188:191], v[224:239]
    s_waitcnt lgkmcnt(4)
    v_fmac_f32 v172, v54, v170
    v_fmac_f32 v173, v54, v171
    v_fmac_f32 v172, v14, v171
    v_fmac_f32 v173, v55, v170
    v_fmac_f32 v174, v54, v172
    v_fmac_f32 v175, v54, v173
    v_mfma_f32_32x32x16_bf16 v[208:223], v[124:127], a[60:63], v[208:223]
    buffer_load_dwordx4 v11, s[48:51], s99 offen offset:2048 lds
    v_fmac_f32 v174, v14, v173
    v_fmac_f32 v175, v55, v172
    v_mov_b32 v176, v174
    v_mov_b32 v177, s85
    v_mov_b32 v178, v175
    v_mov_b32 v179, s85
    v_mfma_f32_32x32x16_bf16 v[240:255], v[124:127], a[188:191], v[240:255]
    s_lshl_b32 s83, s4, 13
    s_lshl_b32 s84, s3, 9
    s_add_u32 s83, s83, s84
    s_add_u32 s83, s83, 65536
    v_lshlrev_b32 v7, 4, v2
    s_mov_b64 exec, s[90:91]
    buffer_store_dwordx4 v[176:179], v7, s[60:63], s83 offen sc1
    s_mov_b64 exec, -1
    ds_read_b64_tr_b16 v[112:113], v34 offset:36864
    ds_read_b64_tr_b16 v[114:115], v34 offset:37376
    ds_read_b64_tr_b16 v[116:117], v34 offset:45056
    ds_read_b64_tr_b16 v[118:119], v34 offset:45568
    v_mfma_f32_32x32x16_bf16 v[192:207], v[96:99], a[64:67], v[192:207]
    v_cndmask_b32 v184, v166, v168, s[88:89]
    v_cndmask_b32 v186, v170, v172, s[88:89]
    v_cndmask_b32 v185, v167, v169, s[88:89]
    v_cndmask_b32 v187, v171, v173, s[88:89]
    v_mfma_f32_32x32x16_bf16 v[224:239], v[96:99], a[192:195], v[224:239]
    buffer_load_dwordx4 v12, s[48:51], s99 offen offset:3072 lds
    s_add_u32 s100, s100, 128
    s_and_b32 s100, s100, 1023
    v_mfma_f32_32x32x16_bf16 v[208:223], v[100:103], a[64:67], v[208:223]
    v_mfma_f32_32x32x16_bf16 v[240:255], v[100:103], a[192:195], v[240:255]
    ds_read_b64_tr_b16 v[120:121], v34 offset:38912
    ds_read_b64_tr_b16 v[122:123], v34 offset:39424
    ds_read_b64_tr_b16 v[124:125], v34 offset:47104
    ds_read_b64_tr_b16 v[126:127], v34 offset:47616
    s_waitcnt lgkmcnt(10)
    v_mfma_f32_32x32x16_bf16 v[192:207], v[104:107], a[68:71], v[192:207]
    v_mfma_f32_32x32x16_bf16 v[224:239], v[104:107], a[196:199], v[224:239]
    s_waitcnt lgkmcnt(8)
    v_mfma_f32_32x32x16_bf16 v[208:223], v[108:111], a[68:71], v[208:223]
    v_mfma_f32_32x32x16_bf16 v[240:255], v[108:111], a[196:199], v[240:255]
    s_waitcnt lgkmcnt(0)
    v_mfma_f32_32x32x16_bf16 v[192:207], v[112:115], a[72:75], v[192:207]
    s_waitcnt vmcnt(9)
    s_barrier
    ds_read_b64_tr_b16 v[96:97], v35 offset:32768
    ds_read_b64_tr_b16 v[98:99], v35 offset:33280
    ds_read_b64_tr_b16 v[100:101], v35 offset:40960
    ds_read_b64_tr_b16 v[102:103], v35 offset:41472
    v_mfma_f32_32x32x16_bf16 v[224:239], v[112:115], a[200:203], v[224:239]
    v_mfma_f32_32x32x16_bf16 v[208:223], v[116:119], a[72:75], v[208:223]
    v_mfma_f32_32x32x16_bf16 v[240:255], v[116:119], a[200:203], v[240:255]
    ds_read_b64_tr_b16 v[104:105], v35 offset:34816
    ds_read_b64_tr_b16 v[106:107], v35 offset:35328
    ds_read_b64_tr_b16 v[108:109], v35 offset:43008
    ds_read_b64_tr_b16 v[110:111], v35 offset:43520
    v_mfma_f32_32x32x16_bf16 v[192:207], v[120:123], a[76:79], v[192:207]
    v_mfma_f32_32x32x16_bf16 v[224:239], v[120:123], a[204:207], v[224:239]
    v_mfma_f32_32x32x16_bf16 v[208:223], v[124:127], a[76:79], v[208:223]
    v_mfma_f32_32x32x16_bf16 v[240:255], v[124:127], a[204:207], v[240:255]
    ds_read_b64_tr_b16 v[112:113], v35 offset:36864
    ds_read_b64_tr_b16 v[114:115], v35 offset:37376
    ds_read_b64_tr_b16 v[116:117], v35 offset:45056
    ds_read_b64_tr_b16 v[118:119], v35 offset:45568
    s_waitcnt lgkmcnt(10)
    v_mfma_f32_32x32x16_bf16 v[192:207], v[96:99], a[80:83], v[192:207]
    v_mfma_f32_32x32x16_bf16 v[224:239], v[96:99], a[208:211], v[224:239]
    s_waitcnt lgkmcnt(8)
    v_mfma_f32_32x32x16_bf16 v[208:223], v[100:103], a[80:83], v[208:223]
    v_mfma_f32_32x32x16_bf16 v[240:255], v[100:103], a[208:211], v[240:255]
    ds_read_b64_tr_b16 v[120:121], v35 offset:38912
    ds_read_b64_tr_b16 v[122:123], v35 offset:39424
    ds_read_b64_tr_b16 v[124:125], v35 offset:47104
    ds_read_b64_tr_b16 v[126:127], v35 offset:47616
    s_waitcnt lgkmcnt(10)
    v_mfma_f32_32x32x16_bf16 v[192:207], v[104:107], a[84:87], v[192:207]
    v_mfma_f32_32x32x16_bf16 v[224:239], v[104:107], a[212:215], v[224:239]
    s_waitcnt lgkmcnt(8)
    v_mfma_f32_32x32x16_bf16 v[208:223], v[108:111], a[84:87], v[208:223]
    v_mfma_f32_32x32x16_bf16 v[240:255], v[108:111], a[212:215], v[240:255]
    s_waitcnt lgkmcnt(0)
    v_mfma_f32_32x32x16_bf16 v[192:207], v[112:115], a[88:91], v[192:207]
    s_waitcnt vmcnt(5)
    s_barrier
    ds_read_b64_tr_b16 v[96:97], v34 offset:49152
    ds_read_b64_tr_b16 v[98:99], v34 offset:49664
    ds_read_b64_tr_b16 v[100:101], v34 offset:57344
    ds_read_b64_tr_b16 v[102:103], v34 offset:57856
    v_mfma_f32_32x32x16_bf16 v[224:239], v[112:115], a[216:219], v[224:239]
    v_mfma_f32_32x32x16_bf16 v[208:223], v[116:119], a[88:91], v[208:223]
    v_mfma_f32_32x32x16_bf16 v[240:255], v[116:119], a[216:219], v[240:255]
    ds_read_b64_tr_b16 v[104:105], v34 offset:51200
    ds_read_b64_tr_b16 v[106:107], v34 offset:51712
    ds_read_b64_tr_b16 v[108:109], v34 offset:59392
    ds_read_b64_tr_b16 v[110:111], v34 offset:59904
    v_mfma_f32_32x32x16_bf16 v[192:207], v[120:123], a[92:95], v[192:207]
    v_mfma_f32_32x32x16_bf16 v[224:239], v[120:123], a[220:223], v[224:239]
    v_mfma_f32_32x32x16_bf16 v[208:223], v[124:127], a[92:95], v[208:223]
    v_mfma_f32_32x32x16_bf16 v[240:255], v[124:127], a[220:223], v[240:255]
    ds_read_b64_tr_b16 v[112:113], v34 offset:53248
    ds_read_b64_tr_b16 v[114:115], v34 offset:53760
    ds_read_b64_tr_b16 v[116:117], v34 offset:61440
    ds_read_b64_tr_b16 v[118:119], v34 offset:61952
    s_waitcnt lgkmcnt(10)
    v_mfma_f32_32x32x16_bf16 v[192:207], v[96:99], a[96:99], v[192:207]
    v_mfma_f32_32x32x16_bf16 v[224:239], v[96:99], a[224:227], v[224:239]
    s_waitcnt lgkmcnt(8)
    v_mfma_f32_32x32x16_bf16 v[208:223], v[100:103], a[96:99], v[208:223]
    v_mfma_f32_32x32x16_bf16 v[240:255], v[100:103], a[224:227], v[240:255]
    ds_read_b64_tr_b16 v[120:121], v34 offset:55296
    ds_read_b64_tr_b16 v[122:123], v34 offset:55808
    ds_read_b64_tr_b16 v[124:125], v34 offset:63488
    ds_read_b64_tr_b16 v[126:127], v34 offset:64000
    s_waitcnt lgkmcnt(10)
    v_mfma_f32_32x32x16_bf16 v[192:207], v[104:107], a[100:103], v[192:207]
    v_mfma_f32_32x32x16_bf16 v[224:239], v[104:107], a[228:231], v[224:239]
    s_waitcnt lgkmcnt(8)
    v_mfma_f32_32x32x16_bf16 v[208:223], v[108:111], a[100:103], v[208:223]
    v_mfma_f32_32x32x16_bf16 v[240:255], v[108:111], a[228:231], v[240:255]
    s_waitcnt lgkmcnt(0)
    v_mfma_f32_32x32x16_bf16 v[192:207], v[112:115], a[104:107], v[192:207]
    s_waitcnt vmcnt(0)
    s_barrier
    ds_read_b64_tr_b16 v[96:97], v35 offset:49152
    ds_read_b64_tr_b16 v[98:99], v35 offset:49664
    ds_read_b64_tr_b16 v[100:101], v35 offset:57344
    ds_read_b64_tr_b16 v[102:103], v35 offset:57856
    v_mfma_f32_32x32x16_bf16 v[224:239], v[112:115], a[232:235], v[224:239]
    v_mfma_f32_32x32x16_bf16 v[208:223], v[116:119], a[104:107], v[208:223]
    v_mfma_f32_32x32x16_bf16 v[240:255], v[116:119], a[232:235], v[240:255]
    ds_read_b64_tr_b16 v[104:105], v35 offset:51200
    ds_read_b64_tr_b16 v[106:107], v35 offset:51712
    ds_read_b64_tr_b16 v[108:109], v35 offset:59392
    ds_read_b64_tr_b16 v[110:111], v35 offset:59904
    v_mfma_f32_32x32x16_bf16 v[192:207], v[120:123], a[108:111], v[192:207]
    v_mfma_f32_32x32x16_bf16 v[224:239], v[120:123], a[236:239], v[224:239]
    v_mfma_f32_32x32x16_bf16 v[208:223], v[124:127], a[108:111], v[208:223]
    v_mfma_f32_32x32x16_bf16 v[240:255], v[124:127], a[236:239], v[240:255]
    ds_read_b64_tr_b16 v[112:113], v35 offset:53248
    ds_read_b64_tr_b16 v[114:115], v35 offset:53760
    ds_read_b64_tr_b16 v[116:117], v35 offset:61440
    ds_read_b64_tr_b16 v[118:119], v35 offset:61952
    s_waitcnt lgkmcnt(10)
    v_mfma_f32_32x32x16_bf16 v[192:207], v[96:99], a[112:115], v[192:207]
    v_mfma_f32_32x32x16_bf16 v[224:239], v[96:99], a[240:243], v[224:239]
    s_waitcnt lgkmcnt(8)
    v_mfma_f32_32x32x16_bf16 v[208:223], v[100:103], a[112:115], v[208:223]
    v_mfma_f32_32x32x16_bf16 v[240:255], v[100:103], a[240:243], v[240:255]
    ds_read_b64_tr_b16 v[120:121], v35 offset:55296
    ds_read_b64_tr_b16 v[122:123], v35 offset:55808
    ds_read_b64_tr_b16 v[124:125], v35 offset:63488
    ds_read_b64_tr_b16 v[126:127], v35 offset:64000
    s_waitcnt lgkmcnt(10)
    v_mfma_f32_32x32x16_bf16 v[192:207], v[104:107], a[116:119], v[192:207]
    v_mfma_f32_32x32x16_bf16 v[224:239], v[104:107], a[244:247], v[224:239]
    s_waitcnt lgkmcnt(8)
    v_mfma_f32_32x32x16_bf16 v[208:223], v[108:111], a[116:119], v[208:223]
    v_mfma_f32_32x32x16_bf16 v[240:255], v[108:111], a[244:247], v[240:255]
    s_waitcnt lgkmcnt(6)
    v_mfma_f32_32x32x16_bf16 v[192:207], v[112:115], a[120:123], v[192:207]
    v_mfma_f32_32x32x16_bf16 v[224:239], v[112:115], a[248:251], v[224:239]
    s_waitcnt lgkmcnt(4)
    v_mfma_f32_32x32x16_bf16 v[208:223], v[116:119], a[120:123], v[208:223]
    v_mfma_f32_32x32x16_bf16 v[240:255], v[116:119], a[248:251], v[240:255]
    s_waitcnt lgkmcnt(2)
    v_mfma_f32_32x32x16_bf16 v[192:207], v[120:123], a[124:127], v[192:207]
    v_mfma_f32_32x32x16_bf16 v[224:239], v[120:123], a[252:255], v[224:239]
    s_waitcnt lgkmcnt(0)
    v_mfma_f32_32x32x16_bf16 v[208:223], v[124:127], a[124:127], v[208:223]
    v_mfma_f32_32x32x16_bf16 v[240:255], v[124:127], a[252:255], v[240:255]
    v_mov_b32 v44, v0
    v_mov_b32 v45, v16
    v_mov_b32 v48, v18
    v_mov_b32 v49, v5
    v_mfma_f32_32x32x16_bf16 v[192:207], v[44:47], v[36:39], v[192:207]
    v_mfma_f32_32x32x16_bf16 v[224:239], v[44:47], v[40:43], v[224:239]
    v_mfma_f32_32x32x16_bf16 v[208:223], v[48:51], v[36:39], v[208:223]
    v_mfma_f32_32x32x16_bf16 v[240:255], v[48:51], v[40:43], v[240:255]
    s_barrier
    v_lshlrev_b32 v7, 4, v2
    s_lshl_b32 s83, s4, 13
    s_add_u32 s83, s83, 65536
    s_lshl_b32 s84, s2, 9
    s_add_u32 s84, s84, 262144
    s_sub_u32 s92, s3, 15
    s_lshl_b32 s92, s92, 9
    s_add_u32 s92, s92, s83
    s_add_u32 s93, s92, 0
    s_cmp_ge_u32 s3, 15
    s_cselect_b32 s93, s93, s84
    buffer_load_dwordx4 v[96:99], v7, s[60:63], s93 offen sc1
    s_add_u32 s93, s92, 512
    s_cmp_ge_u32 s3, 14
    s_cselect_b32 s93, s93, s84
    buffer_load_dwordx4 v[100:103], v7, s[60:63], s93 offen sc1
    s_add_u32 s93, s92, 1024
    s_cmp_ge_u32 s3, 13
    s_cselect_b32 s93, s93, s84
    buffer_load_dwordx4 v[104:107], v7, s[60:63], s93 offen sc1
    s_add_u32 s93, s92, 1536
    s_cmp_ge_u32 s3, 12
    s_cselect_b32 s93, s93, s84
    buffer_load_dwordx4 v[108:111], v7, s[60:63], s93 offen sc1
    s_add_u32 s93, s92, 2048
    s_cmp_ge_u32 s3, 11
    s_cselect_b32 s93, s93, s84
    buffer_load_dwordx4 v[112:115], v7, s[60:63], s93 offen sc1
    s_add_u32 s93, s92, 2560
    s_cmp_ge_u32 s3, 10
    s_cselect_b32 s93, s93, s84
    buffer_load_dwordx4 v[116:119], v7, s[60:63], s93 offen sc1
    s_add_u32 s93, s92, 3072
    s_cmp_ge_u32 s3, 9
    s_cselect_b32 s93, s93, s84
    buffer_load_dwordx4 v[120:123], v7, s[60:63], s93 offen sc1
    s_add_u32 s93, s92, 3584
    s_cmp_ge_u32 s3, 8
    s_cselect_b32 s93, s93, s84
    buffer_load_dwordx4 v[124:127], v7, s[60:63], s93 offen sc1
    s_add_u32 s93, s92, 4096
    s_cmp_ge_u32 s3, 7
    s_cselect_b32 s93, s93, s84
    buffer_load_dwordx4 v[160:163], v7, s[60:63], s93 offen sc1
    s_add_u32 s93, s92, 4608
    s_cmp_ge_u32 s3, 6
    s_cselect_b32 s93, s93, s84
    buffer_load_dwordx4 v[164:167], v7, s[60:63], s93 offen sc1
    s_add_u32 s93, s92, 5120
    s_cmp_ge_u32 s3, 5
    s_cselect_b32 s93, s93, s84
    buffer_load_dwordx4 v[168:171], v7, s[60:63], s93 offen sc1
    s_add_u32 s93, s92, 5632
    s_cmp_ge_u32 s3, 4
    s_cselect_b32 s93, s93, s84
    buffer_load_dwordx4 v[172:175], v7, s[60:63], s93 offen sc1
    s_add_u32 s93, s92, 6144
    s_cmp_ge_u32 s3, 3
    s_cselect_b32 s93, s93, s84
    buffer_load_dwordx4 v[176:179], v7, s[60:63], s93 offen sc1
    s_add_u32 s93, s92, 6656
    s_cmp_ge_u32 s3, 2
    s_cselect_b32 s93, s93, s84
    buffer_load_dwordx4 v[180:183], v7, s[60:63], s93 offen sc1
    s_add_u32 s93, s92, 7168
    s_cmp_ge_u32 s3, 1
    s_cselect_b32 s93, s93, s84
    buffer_load_dwordx4 v[20:23], v7, s[60:63], s93 offen sc1
    s_lshl_b32 s78, s5, 15
    v_lshrrev_b32 v26, 3, v1
    v_bfe_u32 v4, v1, 4, 1
    v_lshlrev_b32 v4, 2, v4
    v_and_b32 v6, 7, v1
    v_xor_b32 v4, v4, v6
    v_lshlrev_b32 v4, 4, v4
    v_lshl_add_u32 v5, v26, 10, v4
    v_add_u32 v6, 7168, v5
    s_mov_b32 s44, s32
    s_mov_b32 s45, s33
    s_mov_b32 s46, 1409024
    s_mov_b32 s47, 0x20000
    s_and_b32 s76, s4, 7
    s_lshl_b32 s77, s76, 7
    s_lshl_b32 s99, s5, 14
    s_add_u32 s77, s77, s99
    v_mov_b32 v36, v28
    s_add_u32 m0, s78, 0
    s_nop 0
    buffer_load_dwordx4 v5, s[44:47], s77 offen lds
    v_mov_b32 v37, v30
    v_mov_b32 v38, v32
    v_mov_b32 v40, v29
    buffer_load_dwordx4 v6, s[44:47], s77 offen offset:1024 lds
    s_add_u32 s77, s77, 65536
    v_mov_b32 v41, v31
    v_mov_b32 v42, v33
    s_add_u32 m0, s78, 2048
    s_nop 0
    buffer_load_dwordx4 v5, s[44:47], s77 offen lds
    v_pk_mul_f32 v[44:45], v[192:193], v[192:193]
    v_pk_mul_f32 v[48:49], v[224:225], v[224:225]
    buffer_load_dwordx4 v6, s[44:47], s77 offen offset:1024 lds
    s_add_u32 s77, s77, 65536
    v_pk_mul_f32 v[46:47], v[194:195], v[194:195]
    v_pk_mul_f32 v[50:51], v[226:227], v[226:227]
    s_add_u32 m0, s78, 4096
    s_nop 0
    buffer_load_dwordx4 v5, s[44:47], s77 offen lds
    v_pk_fma_f32 v[44:45], v[44:45], v[36:37], v[36:37] op_sel:[0,1,0] op_sel_hi:[1,1,0]
    v_pk_fma_f32 v[48:49], v[48:49], v[40:41], v[40:41] op_sel:[0,1,0] op_sel_hi:[1,1,0]
    buffer_load_dwordx4 v6, s[44:47], s77 offen offset:1024 lds
    s_add_u32 s77, s77, 65536
    v_pk_fma_f32 v[46:47], v[46:47], v[36:37], v[36:37] op_sel:[0,1,0] op_sel_hi:[1,1,0]
    v_pk_fma_f32 v[50:51], v[50:51], v[40:41], v[40:41] op_sel:[0,1,0] op_sel_hi:[1,1,0]
    s_add_u32 m0, s78, 6144
    s_nop 0
    buffer_load_dwordx4 v5, s[44:47], s77 offen lds
    v_pk_mul_f32 v[44:45], v[44:45], v[192:193]
    v_pk_mul_f32 v[48:49], v[48:49], v[224:225]
    v_pk_mul_f32 v[46:47], v[46:47], v[194:195]
    buffer_load_dwordx4 v6, s[44:47], s77 offen offset:1024 lds
    s_add_u32 s77, s77, 65536
    v_pk_mul_f32 v[50:51], v[50:51], v[226:227]
    v_exp_f32 v44, v44
    s_add_u32 m0, s78, 8192
    s_nop 0
    buffer_load_dwordx4 v5, s[44:47], s77 offen lds
    v_exp_f32 v48, v48
    v_exp_f32 v45, v45
    buffer_load_dwordx4 v6, s[44:47], s77 offen offset:1024 lds
    s_add_u32 s77, s77, 65536
    v_exp_f32 v49, v49
    v_exp_f32 v46, v46
    s_add_u32 m0, s78, 10240
    s_nop 0
    buffer_load_dwordx4 v5, s[44:47], s77 offen lds
    v_exp_f32 v50, v50
    v_exp_f32 v47, v47
    buffer_load_dwordx4 v6, s[44:47], s77 offen offset:1024 lds
    s_add_u32 s77, s77, 65536
    v_exp_f32 v51, v51
    v_pk_mul_f32 v[208:209], v[208:209], v[192:193]
    s_add_u32 m0, s78, 12288
    s_nop 0
    buffer_load_dwordx4 v5, s[44:47], s77 offen lds
    v_pk_mul_f32 v[240:241], v[240:241], v[224:225]
    v_pk_mul_f32 v[210:211], v[210:211], v[194:195]
    v_pk_mul_f32 v[242:243], v[242:243], v[226:227]
    buffer_load_dwordx4 v6, s[44:47], s77 offen offset:1024 lds
    s_add_u32 s77, s77, 65536
    v_pk_fma_f32 v[44:45], v[44:45], v[38:39], v[38:39] op_sel_hi:[1,0,0]
    v_pk_fma_f32 v[48:49], v[48:49], v[42:43], v[42:43] op_sel_hi:[1,0,0]
    s_add_u32 m0, s78, 14336
    s_nop 0
    buffer_load_dwordx4 v5, s[44:47], s77 offen lds
    v_pk_fma_f32 v[46:47], v[46:47], v[38:39], v[38:39] op_sel_hi:[1,0,0]
    v_pk_fma_f32 v[50:51], v[50:51], v[42:43], v[42:43] op_sel_hi:[1,0,0]
    buffer_load_dwordx4 v6, s[44:47], s77 offen offset:1024 lds
    s_add_u32 s77, s77, 65536
    v_rcp_f32 v44, v44
    v_rcp_f32 v48, v48
    s_add_u32 m0, s78, 16384
    s_nop 0
    buffer_load_dwordx4 v5, s[44:47], s77 offen lds
    v_rcp_f32 v45, v45
    v_rcp_f32 v49, v49
    buffer_load_dwordx4 v6, s[44:47], s77 offen offset:1024 lds
    s_add_u32 s77, s77, 65536
    v_rcp_f32 v46, v46
    v_rcp_f32 v50, v50
    s_add_u32 m0, s78, 18432
    s_nop 0
    buffer_load_dwordx4 v5, s[44:47], s77 offen lds
    v_rcp_f32 v47, v47
    v_rcp_f32 v51, v51
    v_pk_mul_f32 v[208:209], v[208:209], v[44:45]
    buffer_load_dwordx4 v6, s[44:47], s77 offen offset:1024 lds
    s_add_u32 s77, s77, 65536
    v_pk_mul_f32 v[240:241], v[240:241], v[48:49]
    v_pk_mul_f32 v[210:211], v[210:211], v[46:47]
    s_add_u32 m0, s78, 20480
    s_nop 0
    buffer_load_dwordx4 v5, s[44:47], s77 offen lds
    v_pk_mul_f32 v[242:243], v[242:243], v[50:51]
    v_cvt_pk_bf16_f32 v192, v208, v209
    buffer_load_dwordx4 v6, s[44:47], s77 offen offset:1024 lds
    s_add_u32 s77, s77, 65536
    v_cvt_pk_bf16_f32 v224, v240, v241
    v_cvt_pk_bf16_f32 v193, v210, v211
    s_add_u32 m0, s78, 22528
    s_nop 0
    buffer_load_dwordx4 v5, s[44:47], s77 offen lds
    v_cvt_pk_bf16_f32 v225, v242, v243
    v_pk_mul_f32 v[44:45], v[196:197], v[196:197]
    buffer_load_dwordx4 v6, s[44:47], s77 offen offset:1024 lds
    s_add_u32 s77, s77, 65536
    v_pk_mul_f32 v[48:49], v[228:229], v[228:229]
    v_pk_mul_f32 v[46:47], v[198:199], v[198:199]
    s_add_u32 m0, s78, 24576
    s_nop 0
    buffer_load_dwordx4 v5, s[44:47], s77 offen lds
    v_pk_mul_f32 v[50:51], v[230:231], v[230:231]
    v_pk_fma_f32 v[44:45], v[44:45], v[36:37], v[36:37] op_sel:[0,1,0] op_sel_hi:[1,1,0]
    v_pk_fma_f32 v[48:49], v[48:49], v[40:41], v[40:41] op_sel:[0,1,0] op_sel_hi:[1,1,0]
    buffer_load_dwordx4 v6, s[44:47], s77 offen offset:1024 lds
    s_add_u32 s77, s77, 65536
    v_pk_fma_f32 v[46:47], v[46:47], v[36:37], v[36:37] op_sel:[0,1,0] op_sel_hi:[1,1,0]
    v_pk_fma_f32 v[50:51], v[50:51], v[40:41], v[40:41] op_sel:[0,1,0] op_sel_hi:[1,1,0]
    s_add_u32 m0, s78, 26624
    s_nop 0
    buffer_load_dwordx4 v5, s[44:47], s77 offen lds
    v_pk_mul_f32 v[44:45], v[44:45], v[196:197]
    v_pk_mul_f32 v[48:49], v[48:49], v[228:229]
    buffer_load_dwordx4 v6, s[44:47], s77 offen offset:1024 lds
    s_add_u32 s77, s77, 65536
    v_pk_mul_f32 v[46:47], v[46:47], v[198:199]
    v_pk_mul_f32 v[50:51], v[50:51], v[230:231]
    s_add_u32 m0, s78, 28672
    s_nop 0
    buffer_load_dwordx4 v5, s[44:47], s77 offen lds
    v_exp_f32 v44, v44
    v_exp_f32 v48, v48
    buffer_load_dwordx4 v6, s[44:47], s77 offen offset:1024 lds
    s_add_u32 s77, s77, 65536
    v_exp_f32 v45, v45
    v_exp_f32 v49, v49
    s_add_u32 m0, s78, 30720
    s_nop 0
    buffer_load_dwordx4 v5, s[44:47], s77 offen lds
    v_exp_f32 v46, v46
    v_exp_f32 v50, v50
    v_exp_f32 v47, v47
    buffer_load_dwordx4 v6, s[44:47], s77 offen offset:1024 lds
    s_add_u32 s77, s77, 65536
    v_exp_f32 v51, v51
    v_pk_mul_f32 v[212:213], v[212:213], v[196:197]
    v_bfe_u32 v26, v1, 2, 2
    v_pk_mul_f32 v[244:245], v[244:245], v[228:229]
    v_pk_mul_f32 v[214:215], v[214:215], v[198:199]
    v_bfe_u32 v4, v1, 5, 1
    v_pk_mul_f32 v[246:247], v[246:247], v[230:231]
    v_pk_fma_f32 v[44:45], v[44:45], v[38:39], v[38:39] op_sel_hi:[1,0,0]
    v_lshl_add_u32 v26, v4, 2, v26
    v_pk_fma_f32 v[48:49], v[48:49], v[42:43], v[42:43] op_sel_hi:[1,0,0]
    v_pk_fma_f32 v[46:47], v[46:47], v[38:39], v[38:39] op_sel_hi:[1,0,0]
    v_lshlrev_b32 v26, 7, v26
    v_pk_fma_f32 v[50:51], v[50:51], v[42:43], v[42:43] op_sel_hi:[1,0,0]
    v_rcp_f32 v44, v44
    v_bfe_u32 v4, v1, 4, 1
    v_rcp_f32 v48, v48
    v_rcp_f32 v45, v45
    v_rcp_f32 v49, v49
    v_lshlrev_b32 v4, 1, v4
    v_rcp_f32 v46, v46
    v_rcp_f32 v50, v50
    v_bfe_u32 v10, v1, 1, 1
    v_rcp_f32 v47, v47
    v_rcp_f32 v51, v51
    v_add_u32 v4, v4, v10
    v_pk_mul_f32 v[212:213], v[212:213], v[44:45]
    v_pk_mul_f32 v[244:245], v[244:245], v[48:49]
    v_bfe_u32 v10, v1, 3, 1
    v_pk_mul_f32 v[214:215], v[214:215], v[46:47]
    v_pk_mul_f32 v[246:247], v[246:247], v[50:51]
    v_lshlrev_b32 v10, 2, v10
    v_cvt_pk_bf16_f32 v194, v212, v213
    v_cvt_pk_bf16_f32 v226, v244, v245
    v_xor_b32 v4, v4, v10
    v_cvt_pk_bf16_f32 v195, v214, v215
    v_cvt_pk_bf16_f32 v227, v246, v247
    buffer_store_dwordx4 v[192:195], v27, s[52:55], s82 offen offset:0 sc1
    v_lshl_add_u32 v26, v4, 4, v26
    buffer_store_dwordx4 v[224:227], v27, s[56:59], s82 offen offset:0 sc1
    v_pk_mul_f32 v[44:45], v[200:201], v[200:201]
    v_and_b32 v4, 1, v1
    v_pk_mul_f32 v[48:49], v[232:233], v[232:233]
    v_pk_mul_f32 v[46:47], v[202:203], v[202:203]
    v_lshl_add_u32 v26, v4, 3, v26
    v_pk_mul_f32 v[50:51], v[234:235], v[234:235]
    v_pk_fma_f32 v[44:45], v[44:45], v[36:37], v[36:37] op_sel:[0,1,0] op_sel_hi:[1,1,0]
    v_add_u32 v9, s78, v26
    v_pk_fma_f32 v[48:49], v[48:49], v[40:41], v[40:41] op_sel:[0,1,0] op_sel_hi:[1,1,0]
    v_pk_fma_f32 v[46:47], v[46:47], v[36:37], v[36:37] op_sel:[0,1,0] op_sel_hi:[1,1,0]
    v_xor_b32 v10, 64, v9
    v_pk_fma_f32 v[50:51], v[50:51], v[40:41], v[40:41] op_sel:[0,1,0] op_sel_hi:[1,1,0]
    v_pk_mul_f32 v[44:45], v[44:45], v[200:201]
    s_bitcmp1_b32 s5, 0
    s_cselect_b32 s48, s20, s18
    s_cselect_b32 s49, s21, s19
    v_pk_mul_f32 v[48:49], v[48:49], v[232:233]
    v_pk_mul_f32 v[46:47], v[46:47], v[202:203]
    s_mov_b32 s50, 524288
    v_pk_mul_f32 v[50:51], v[50:51], v[234:235]
    v_exp_f32 v44, v44
    v_exp_f32 v48, v48
    s_mov_b32 s51, 0x20000
    v_exp_f32 v45, v45
    v_exp_f32 v49, v49
    v_and_b32 v4, 7, v1
    v_exp_f32 v46, v46
    v_exp_f32 v50, v50
    v_lshrrev_b32 v26, 4, v1
    v_exp_f32 v47, v47
    v_exp_f32 v51, v51
    v_xor_b32 v4, v4, v26
    v_pk_mul_f32 v[216:217], v[216:217], v[200:201]
    v_pk_mul_f32 v[248:249], v[248:249], v[232:233]
    v_lshlrev_b32 v4, 4, v4
    v_pk_mul_f32 v[218:219], v[218:219], v[202:203]
    v_pk_mul_f32 v[250:251], v[250:251], v[234:235]
    v_lshrrev_b32 v26, 3, v1
    v_pk_fma_f32 v[44:45], v[44:45], v[38:39], v[38:39] op_sel_hi:[1,0,0]
    v_pk_fma_f32 v[48:49], v[48:49], v[42:43], v[42:43] op_sel_hi:[1,0,0]
    v_pk_fma_f32 v[46:47], v[46:47], v[38:39], v[38:39] op_sel_hi:[1,0,0]
    v_lshl_add_u32 v11, v26, 10, v4
    v_pk_fma_f32 v[50:51], v[50:51], v[42:43], v[42:43] op_sel_hi:[1,0,0]
    v_rcp_f32 v44, v44
    v_xor_b32 v12, 64, v11
    v_rcp_f32 v48, v48
    v_rcp_f32 v45, v45
    v_add_u32 v13, 14336, v11
    v_rcp_f32 v49, v49
    v_rcp_f32 v46, v46
    v_add_u32 v14, 21504, v12
    v_rcp_f32 v50, v50
    v_rcp_f32 v47, v47
    v_add_u32 v12, 7168, v12
    v_rcp_f32 v51, v51
    v_pk_mul_f32 v[216:217], v[216:217], v[44:45]
    s_and_b32 s76, s4, 7
    v_pk_mul_f32 v[248:249], v[248:249], v[48:49]
    v_pk_mul_f32 v[218:219], v[218:219], v[46:47]
    v_pk_mul_f32 v[250:251], v[250:251], v[50:51]
    s_lshl_b32 s79, s76, 16
    v_cvt_pk_bf16_f32 v200, v216, v217
    v_cvt_pk_bf16_f32 v232, v248, v249
    s_lshr_b32 s99, s5, 1
    v_cvt_pk_bf16_f32 v201, v218, v219
    v_cvt_pk_bf16_f32 v233, v250, v251
    s_lshl_b32 s99, s99, 7
    v_pk_mul_f32 v[44:45], v[204:205], v[204:205]
    v_pk_mul_f32 v[48:49], v[236:237], v[236:237]
    s_add_u32 s79, s79, s99
    v_pk_mul_f32 v[46:47], v[206:207], v[206:207]
    v_pk_mul_f32 v[50:51], v[238:239], v[238:239]
    v_and_b32 v26, 31, v1
    v_pk_fma_f32 v[44:45], v[44:45], v[36:37], v[36:37] op_sel:[0,1,0] op_sel_hi:[1,1,0]
    v_pk_fma_f32 v[48:49], v[48:49], v[40:41], v[40:41] op_sel:[0,1,0] op_sel_hi:[1,1,0]
    v_lshrrev_b32 v4, 5, v1
    v_pk_fma_f32 v[46:47], v[46:47], v[36:37], v[36:37] op_sel:[0,1,0] op_sel_hi:[1,1,0]
    v_pk_fma_f32 v[50:51], v[50:51], v[40:41], v[40:41] op_sel:[0,1,0] op_sel_hi:[1,1,0]
    v_pk_mul_f32 v[44:45], v[44:45], v[204:205]
    v_bfe_u32 v25, v26, 1, 3
    v_pk_mul_f32 v[48:49], v[48:49], v[236:237]
    v_pk_mul_f32 v[46:47], v[46:47], v[206:207]
    v_lshlrev_b32 v26, 7, v26
    v_pk_mul_f32 v[50:51], v[50:51], v[238:239]
    v_exp_f32 v44, v44
    v_or_b32 v15, 0, v4
    v_exp_f32 v48, v48
    v_exp_f32 v45, v45
    v_xor_b32 v15, v15, v25
    v_exp_f32 v49, v49
    v_exp_f32 v46, v46
    v_lshl_add_u32 v15, v15, 4, v26
    v_exp_f32 v50, v50
    v_exp_f32 v47, v47
    v_or_b32 v16, 2, v4
    v_exp_f32 v51, v51
    v_pk_mul_f32 v[220:221], v[220:221], v[204:205]
    v_pk_mul_f32 v[252:253], v[252:253], v[236:237]
    v_xor_b32 v16, v16, v25
    v_pk_mul_f32 v[222:223], v[222:223], v[206:207]
    v_pk_mul_f32 v[254:255], v[254:255], v[238:239]
    v_lshl_add_u32 v16, v16, 4, v26
    v_pk_fma_f32 v[44:45], v[44:45], v[38:39], v[38:39] op_sel_hi:[1,0,0]
    v_pk_fma_f32 v[48:49], v[48:49], v[42:43], v[42:43] op_sel_hi:[1,0,0]
    v_or_b32 v24, 4, v4
    v_pk_fma_f32 v[46:47], v[46:47], v[38:39], v[38:39] op_sel_hi:[1,0,0]
    v_pk_fma_f32 v[50:51], v[50:51], v[42:43], v[42:43] op_sel_hi:[1,0,0]
    v_xor_b32 v24, v24, v25
    v_rcp_f32 v44, v44
    v_rcp_f32 v48, v48
    v_lshl_add_u32 v24, v24, 4, v26
    v_rcp_f32 v45, v45
    v_rcp_f32 v49, v49
    v_or_b32 v4, 6, v4
    v_rcp_f32 v46, v46
    v_rcp_f32 v50, v50
    v_rcp_f32 v47, v47
    v_xor_b32 v25, v4, v25
    v_rcp_f32 v51, v51
    v_pk_mul_f32 v[220:221], v[220:221], v[44:45]
    v_lshl_add_u32 v25, v25, 4, v26
    v_pk_mul_f32 v[252:253], v[252:253], v[48:49]
    v_pk_mul_f32 v[222:223], v[222:223], v[46:47]
    v_add_u32 v15, s78, v15
    v_pk_mul_f32 v[254:255], v[254:255], v[50:51]
    v_cvt_pk_bf16_f32 v202, v220, v221
    v_add_u32 v16, s78, v16
    v_cvt_pk_bf16_f32 v234, v252, v253
    v_cvt_pk_bf16_f32 v203, v222, v223
    v_add_u32 v24, s78, v24
    v_cvt_pk_bf16_f32 v235, v254, v255
    buffer_store_dwordx4 v[200:203], v27, s[52:55], s82 offen offset:1024 sc1
    v_add_u32 v25, s78, v25
    buffer_store_dwordx4 v[232:235], v27, s[56:59], s82 offen offset:1024 sc1
    v_mov_b32 v8, 0
    s_waitcnt vmcnt(50)
    v_bitop3_b32 v8, v8, v97, s85 bitop3:0xf6
    v_bitop3_b32 v8, v8, v99, s85 bitop3:0xf6
    s_waitcnt vmcnt(49)
    v_bitop3_b32 v8, v8, v101, s85 bitop3:0xf6
    v_bitop3_b32 v8, v8, v103, s85 bitop3:0xf6
    s_waitcnt vmcnt(48)
    v_bitop3_b32 v8, v8, v105, s85 bitop3:0xf6
    v_bitop3_b32 v8, v8, v107, s85 bitop3:0xf6
    s_waitcnt vmcnt(47)
    v_bitop3_b32 v8, v8, v109, s85 bitop3:0xf6
    v_bitop3_b32 v8, v8, v111, s85 bitop3:0xf6
    s_waitcnt vmcnt(46)
    v_bitop3_b32 v8, v8, v113, s85 bitop3:0xf6
    v_bitop3_b32 v8, v8, v115, s85 bitop3:0xf6
    s_waitcnt vmcnt(45)
    v_bitop3_b32 v8, v8, v117, s85 bitop3:0xf6
    v_bitop3_b32 v8, v8, v119, s85 bitop3:0xf6
    s_waitcnt vmcnt(44)
    v_bitop3_b32 v8, v8, v121, s85 bitop3:0xf6
    v_bitop3_b32 v8, v8, v123, s85 bitop3:0xf6
    s_waitcnt vmcnt(43)
    v_bitop3_b32 v8, v8, v125, s85 bitop3:0xf6
    v_bitop3_b32 v8, v8, v127, s85 bitop3:0xf6
    s_waitcnt vmcnt(42)
    v_bitop3_b32 v8, v8, v161, s85 bitop3:0xf6
    v_bitop3_b32 v8, v8, v163, s85 bitop3:0xf6
    s_waitcnt vmcnt(41)
    v_bitop3_b32 v8, v8, v165, s85 bitop3:0xf6
    v_bitop3_b32 v8, v8, v167, s85 bitop3:0xf6
    s_waitcnt vmcnt(40)
    v_bitop3_b32 v8, v8, v169, s85 bitop3:0xf6
    v_bitop3_b32 v8, v8, v171, s85 bitop3:0xf6
    s_waitcnt vmcnt(39)
    v_bitop3_b32 v8, v8, v173, s85 bitop3:0xf6
    v_bitop3_b32 v8, v8, v175, s85 bitop3:0xf6
    s_waitcnt vmcnt(38)
    v_bitop3_b32 v8, v8, v177, s85 bitop3:0xf6
    v_bitop3_b32 v8, v8, v179, s85 bitop3:0xf6
    s_waitcnt vmcnt(37)
    v_bitop3_b32 v8, v8, v181, s85 bitop3:0xf6
    v_bitop3_b32 v8, v8, v183, s85 bitop3:0xf6
    s_waitcnt vmcnt(36)
    v_bitop3_b32 v8, v8, v21, s85 bitop3:0xf6
    v_bitop3_b32 v8, v8, v23, s85 bitop3:0xf6
    v_cmp_ne_u32 vcc, 0, v8
    s_cbranch_vccnz L_p1_agslow
L_p1_agok:
    v_mov_b32 v97, v98
    v_mov_b32 v101, v102
    v_mov_b32 v105, v106
    v_mov_b32 v109, v110
    v_mov_b32 v113, v114
    v_mov_b32 v117, v118
    v_mov_b32 v121, v122
    v_mov_b32 v125, v126
    v_mov_b32 v161, v162
    v_mov_b32 v165, v166
    v_mov_b32 v169, v170
    v_mov_b32 v173, v174
    v_mov_b32 v177, v178
    v_mov_b32 v181, v182
    v_mov_b32 v21, v22
    v_pk_fma_f32 v[100:101], v[56:57], v[96:97], v[100:101] op_sel_hi:[0,1,1]
    v_pk_fma_f32 v[100:101], v[56:57], v[96:97], v[100:101] op_sel:[1,1,0] op_sel_hi:[1,0,1] neg_lo:[1,0,0]
    v_pk_fma_f32 v[104:105], v[56:57], v[100:101], v[104:105] op_sel_hi:[0,1,1]
    v_pk_fma_f32 v[104:105], v[56:57], v[100:101], v[104:105] op_sel:[1,1,0] op_sel_hi:[1,0,1] neg_lo:[1,0,0]
    v_pk_fma_f32 v[108:109], v[56:57], v[104:105], v[108:109] op_sel_hi:[0,1,1]
    v_pk_fma_f32 v[108:109], v[56:57], v[104:105], v[108:109] op_sel:[1,1,0] op_sel_hi:[1,0,1] neg_lo:[1,0,0]
    v_pk_fma_f32 v[112:113], v[56:57], v[108:109], v[112:113] op_sel_hi:[0,1,1]
    v_pk_fma_f32 v[112:113], v[56:57], v[108:109], v[112:113] op_sel:[1,1,0] op_sel_hi:[1,0,1] neg_lo:[1,0,0]
    v_pk_fma_f32 v[116:117], v[56:57], v[112:113], v[116:117] op_sel_hi:[0,1,1]
    v_pk_fma_f32 v[116:117], v[56:57], v[112:113], v[116:117] op_sel:[1,1,0] op_sel_hi:[1,0,1] neg_lo:[1,0,0]
    v_pk_fma_f32 v[120:121], v[56:57], v[116:117], v[120:121] op_sel_hi:[0,1,1]
    v_pk_fma_f32 v[120:121], v[56:57], v[116:117], v[120:121] op_sel:[1,1,0] op_sel_hi:[1,0,1] neg_lo:[1,0,0]
    v_pk_fma_f32 v[124:125], v[56:57], v[120:121], v[124:125] op_sel_hi:[0,1,1]
    v_pk_fma_f32 v[124:125], v[56:57], v[120:121], v[124:125] op_sel:[1,1,0] op_sel_hi:[1,0,1] neg_lo:[1,0,0]
    v_pk_fma_f32 v[160:161], v[56:57], v[124:125], v[160:161] op_sel_hi:[0,1,1]
    v_pk_fma_f32 v[160:161], v[56:57], v[124:125], v[160:161] op_sel:[1,1,0] op_sel_hi:[1,0,1] neg_lo:[1,0,0]
    v_pk_fma_f32 v[164:165], v[56:57], v[160:161], v[164:165] op_sel_hi:[0,1,1]
    v_pk_fma_f32 v[164:165], v[56:57], v[160:161], v[164:165] op_sel:[1,1,0] op_sel_hi:[1,0,1] neg_lo:[1,0,0]
    v_pk_fma_f32 v[168:169], v[56:57], v[164:165], v[168:169] op_sel_hi:[0,1,1]
    v_pk_fma_f32 v[168:169], v[56:57], v[164:165], v[168:169] op_sel:[1,1,0] op_sel_hi:[1,0,1] neg_lo:[1,0,0]
    v_pk_fma_f32 v[172:173], v[56:57], v[168:169], v[172:173] op_sel_hi:[0,1,1]
    v_pk_fma_f32 v[172:173], v[56:57], v[168:169], v[172:173] op_sel:[1,1,0] op_sel_hi:[1,0,1] neg_lo:[1,0,0]
    v_pk_fma_f32 v[176:177], v[56:57], v[172:173], v[176:177] op_sel_hi:[0,1,1]
    v_pk_fma_f32 v[176:177], v[56:57], v[172:173], v[176:177] op_sel:[1,1,0] op_sel_hi:[1,0,1] neg_lo:[1,0,0]
    v_pk_fma_f32 v[180:181], v[56:57], v[176:177], v[180:181] op_sel_hi:[0,1,1]
    v_pk_fma_f32 v[180:181], v[56:57], v[176:177], v[180:181] op_sel:[1,1,0] op_sel_hi:[1,0,1] neg_lo:[1,0,0]
    v_pk_fma_f32 v[20:21], v[56:57], v[180:181], v[20:21] op_sel_hi:[0,1,1]
    v_pk_fma_f32 v[20:21], v[56:57], v[180:181], v[20:21] op_sel:[1,1,0] op_sel_hi:[1,0,1] neg_lo:[1,0,0]
    v_pk_fma_f32 v[184:185], v[60:61], v[20:21], v[184:185] op_sel_hi:[0,1,1]
    v_pk_fma_f32 v[184:185], v[60:61], v[20:21], v[184:185] op_sel:[1,1,0] op_sel_hi:[1,0,1] neg_lo:[1,0,0]
    v_pk_fma_f32 v[186:187], v[62:63], v[20:21], v[186:187] op_sel_hi:[0,1,1]
    v_pk_fma_f32 v[186:187], v[62:63], v[20:21], v[186:187] op_sel:[1,1,0] op_sel_hi:[1,0,1] neg_lo:[1,0,0]
    v_pk_fma_f32 v[64:65], v[52:53], v[184:185], v[64:65] op_sel_hi:[0,1,1]
    v_pk_fma_f32 v[64:65], v[52:53], v[184:185], v[64:65] op_sel:[1,1,0] op_sel_hi:[1,0,1] neg_lo:[1,0,0]
    v_pk_fma_f32 v[128:129], v[52:53], v[186:187], v[128:129] op_sel_hi:[0,1,1]
    v_pk_fma_f32 v[128:129], v[52:53], v[186:187], v[128:129] op_sel:[1,1,0] op_sel_hi:[1,0,1] neg_lo:[1,0,0]
    v_pk_fma_f32 v[66:67], v[52:53], v[64:65], v[66:67] op_sel_hi:[0,1,1]
    v_pk_fma_f32 v[66:67], v[52:53], v[64:65], v[66:67] op_sel:[1,1,0] op_sel_hi:[1,0,1] neg_lo:[1,0,0]
    v_pk_fma_f32 v[130:131], v[52:53], v[128:129], v[130:131] op_sel_hi:[0,1,1]
    v_pk_fma_f32 v[130:131], v[52:53], v[128:129], v[130:131] op_sel:[1,1,0] op_sel_hi:[1,0,1] neg_lo:[1,0,0]
    v_pk_fma_f32 v[68:69], v[52:53], v[66:67], v[68:69] op_sel_hi:[0,1,1]
    v_pk_fma_f32 v[68:69], v[52:53], v[66:67], v[68:69] op_sel:[1,1,0] op_sel_hi:[1,0,1] neg_lo:[1,0,0]
    v_pk_fma_f32 v[132:133], v[52:53], v[130:131], v[132:133] op_sel_hi:[0,1,1]
    v_pk_fma_f32 v[132:133], v[52:53], v[130:131], v[132:133] op_sel:[1,1,0] op_sel_hi:[1,0,1] neg_lo:[1,0,0]
    v_pk_fma_f32 v[70:71], v[52:53], v[68:69], v[70:71] op_sel_hi:[0,1,1]
    v_pk_fma_f32 v[70:71], v[52:53], v[68:69], v[70:71] op_sel:[1,1,0] op_sel_hi:[1,0,1] neg_lo:[1,0,0]
    v_pk_fma_f32 v[134:135], v[52:53], v[132:133], v[134:135] op_sel_hi:[0,1,1]
    v_pk_fma_f32 v[134:135], v[52:53], v[132:133], v[134:135] op_sel:[1,1,0] op_sel_hi:[1,0,1] neg_lo:[1,0,0]
    v_pk_fma_f32 v[72:73], v[52:53], v[70:71], v[72:73] op_sel_hi:[0,1,1]
    v_pk_fma_f32 v[72:73], v[52:53], v[70:71], v[72:73] op_sel:[1,1,0] op_sel_hi:[1,0,1] neg_lo:[1,0,0]
    v_pk_fma_f32 v[136:137], v[52:53], v[134:135], v[136:137] op_sel_hi:[0,1,1]
    v_pk_fma_f32 v[136:137], v[52:53], v[134:135], v[136:137] op_sel:[1,1,0] op_sel_hi:[1,0,1] neg_lo:[1,0,0]
    v_pk_fma_f32 v[74:75], v[52:53], v[72:73], v[74:75] op_sel_hi:[0,1,1]
    v_pk_fma_f32 v[74:75], v[52:53], v[72:73], v[74:75] op_sel:[1,1,0] op_sel_hi:[1,0,1] neg_lo:[1,0,0]
    v_pk_fma_f32 v[138:139], v[52:53], v[136:137], v[138:139] op_sel_hi:[0,1,1]
    v_pk_fma_f32 v[138:139], v[52:53], v[136:137], v[138:139] op_sel:[1,1,0] op_sel_hi:[1,0,1] neg_lo:[1,0,0]
    v_pk_fma_f32 v[76:77], v[52:53], v[74:75], v[76:77] op_sel_hi:[0,1,1]
    v_pk_fma_f32 v[76:77], v[52:53], v[74:75], v[76:77] op_sel:[1,1,0] op_sel_hi:[1,0,1] neg_lo:[1,0,0]
    v_pk_fma_f32 v[140:141], v[52:53], v[138:139], v[140:141] op_sel_hi:[0,1,1]
    v_pk_fma_f32 v[140:141], v[52:53], v[138:139], v[140:141] op_sel:[1,1,0] op_sel_hi:[1,0,1] neg_lo:[1,0,0]
    v_pk_fma_f32 v[78:79], v[52:53], v[76:77], v[78:79] op_sel_hi:[0,1,1]
    v_pk_fma_f32 v[78:79], v[52:53], v[76:77], v[78:79] op_sel:[1,1,0] op_sel_hi:[1,0,1] neg_lo:[1,0,0]
    v_pk_fma_f32 v[142:143], v[52:53], v[140:141], v[142:143] op_sel_hi:[0,1,1]
    v_pk_fma_f32 v[142:143], v[52:53], v[140:141], v[142:143] op_sel:[1,1,0] op_sel_hi:[1,0,1] neg_lo:[1,0,0]
    v_pk_fma_f32 v[80:81], v[52:53], v[78:79], v[80:81] op_sel_hi:[0,1,1]
    v_pk_fma_f32 v[80:81], v[52:53], v[78:79], v[80:81] op_sel:[1,1,0] op_sel_hi:[1,0,1] neg_lo:[1,0,0]
    v_pk_fma_f32 v[144:145], v[52:53], v[142:143], v[144:145] op_sel_hi:[0,1,1]
    v_pk_fma_f32 v[144:145], v[52:53], v[142:143], v[144:145] op_sel:[1,1,0] op_sel_hi:[1,0,1] neg_lo:[1,0,0]
    v_pk_fma_f32 v[82:83], v[52:53], v[80:81], v[82:83] op_sel_hi:[0,1,1]
    v_pk_fma_f32 v[82:83], v[52:53], v[80:81], v[82:83] op_sel:[1,1,0] op_sel_hi:[1,0,1] neg_lo:[1,0,0]
    v_pk_fma_f32 v[146:147], v[52:53], v[144:145], v[146:147] op_sel_hi:[0,1,1]
    v_pk_fma_f32 v[146:147], v[52:53], v[144:145], v[146:147] op_sel:[1,1,0] op_sel_hi:[1,0,1] neg_lo:[1,0,0]
    v_pk_fma_f32 v[84:85], v[52:53], v[82:83], v[84:85] op_sel_hi:[0,1,1]
    v_pk_fma_f32 v[84:85], v[52:53], v[82:83], v[84:85] op_sel:[1,1,0] op_sel_hi:[1,0,1] neg_lo:[1,0,0]
    v_pk_fma_f32 v[148:149], v[52:53], v[146:147], v[148:149] op_sel_hi:[0,1,1]
    v_pk_fma_f32 v[148:149], v[52:53], v[146:147], v[148:149] op_sel:[1,1,0] op_sel_hi:[1,0,1] neg_lo:[1,0,0]
    v_pk_fma_f32 v[86:87], v[52:53], v[84:85], v[86:87] op_sel_hi:[0,1,1]
    v_pk_fma_f32 v[86:87], v[52:53], v[84:85], v[86:87] op_sel:[1,1,0] op_sel_hi:[1,0,1] neg_lo:[1,0,0]
    v_pk_fma_f32 v[150:151], v[52:53], v[148:149], v[150:151] op_sel_hi:[0,1,1]
    v_pk_fma_f32 v[150:151], v[52:53], v[148:149], v[150:151] op_sel:[1,1,0] op_sel_hi:[1,0,1] neg_lo:[1,0,0]
    v_pk_fma_f32 v[88:89], v[52:53], v[86:87], v[88:89] op_sel_hi:[0,1,1]
    v_pk_fma_f32 v[88:89], v[52:53], v[86:87], v[88:89] op_sel:[1,1,0] op_sel_hi:[1,0,1] neg_lo:[1,0,0]
    v_pk_fma_f32 v[152:153], v[52:53], v[150:151], v[152:153] op_sel_hi:[0,1,1]
    v_pk_fma_f32 v[152:153], v[52:53], v[150:151], v[152:153] op_sel:[1,1,0] op_sel_hi:[1,0,1] neg_lo:[1,0,0]
    v_pk_fma_f32 v[90:91], v[52:53], v[88:89], v[90:91] op_sel_hi:[0,1,1]
    v_pk_fma_f32 v[90:91], v[52:53], v[88:89], v[90:91] op_sel:[1,1,0] op_sel_hi:[1,0,1] neg_lo:[1,0,0]
    v_pk_fma_f32 v[154:155], v[52:53], v[152:153], v[154:155] op_sel_hi:[0,1,1]
    v_pk_fma_f32 v[154:155], v[52:53], v[152:153], v[154:155] op_sel:[1,1,0] op_sel_hi:[1,0,1] neg_lo:[1,0,0]
    v_pk_fma_f32 v[92:93], v[52:53], v[90:91], v[92:93] op_sel_hi:[0,1,1]
    v_pk_fma_f32 v[92:93], v[52:53], v[90:91], v[92:93] op_sel:[1,1,0] op_sel_hi:[1,0,1] neg_lo:[1,0,0]
    v_pk_fma_f32 v[156:157], v[52:53], v[154:155], v[156:157] op_sel_hi:[0,1,1]
    v_pk_fma_f32 v[156:157], v[52:53], v[154:155], v[156:157] op_sel:[1,1,0] op_sel_hi:[1,0,1] neg_lo:[1,0,0]
    v_pk_fma_f32 v[94:95], v[52:53], v[92:93], v[94:95] op_sel_hi:[0,1,1]
    v_pk_fma_f32 v[94:95], v[52:53], v[92:93], v[94:95] op_sel:[1,1,0] op_sel_hi:[1,0,1] neg_lo:[1,0,0]
    v_pk_fma_f32 v[158:159], v[52:53], v[156:157], v[158:159] op_sel_hi:[0,1,1]
    v_pk_fma_f32 v[158:159], v[52:53], v[156:157], v[158:159] op_sel:[1,1,0] op_sel_hi:[1,0,1] neg_lo:[1,0,0]
    s_lshl_b32 s83, s6, 13
    s_add_u32 s83, s83, 131072
    v_lshlrev_b32 v7, 6, v2
    v_lshl_add_u32 v7, v3, 5, v7
    v_add_u32 v7, s83, v7
    v_add_u32 v8, s83, v17
    v_lshlrev_b32 v19, 4, v2
    v_lshl_add_u32 v19, v3, 9, v19
    s_lshl_b32 s84, s4, 12
    s_add_u32 s84, s84, 88064
    v_cvt_pk_bf16_f32 v208, v64, v66
    v_cvt_pk_bf16_f32 v216, -v65, -v67
    v_cvt_pk_bf16_f32 v209, v68, v70
    v_cvt_pk_bf16_f32 v217, -v69, -v71
    v_cvt_pk_bf16_f32 v210, v72, v74
    v_cvt_pk_bf16_f32 v218, -v73, -v75
    v_cvt_pk_bf16_f32 v211, v76, v78
    v_cvt_pk_bf16_f32 v219, -v77, -v79
    v_cvt_pk_bf16_f32 v212, v80, v82
    v_cvt_pk_bf16_f32 v220, -v81, -v83
    v_cvt_pk_bf16_f32 v213, v84, v86
    v_cvt_pk_bf16_f32 v221, -v85, -v87
    v_cvt_pk_bf16_f32 v214, v88, v90
    v_cvt_pk_bf16_f32 v222, -v89, -v91
    v_cvt_pk_bf16_f32 v215, v92, v94
    v_cvt_pk_bf16_f32 v223, -v93, -v95
    ds_write_b128 v7, v[208:211] offset:0
    ds_write_b128 v7, v[212:215] offset:16
    ds_write_b128 v7, v[216:219] offset:2048
    ds_write_b128 v7, v[220:223] offset:2064
    v_cvt_pk_bf16_f32 v240, v128, v130
    v_cvt_pk_bf16_f32 v248, -v129, -v131
    v_cvt_pk_bf16_f32 v241, v132, v134
    v_cvt_pk_bf16_f32 v249, -v133, -v135
    v_cvt_pk_bf16_f32 v242, v136, v138
    v_cvt_pk_bf16_f32 v250, -v137, -v139
    v_cvt_pk_bf16_f32 v243, v140, v142
    v_cvt_pk_bf16_f32 v251, -v141, -v143
    v_cvt_pk_bf16_f32 v244, v144, v146
    v_cvt_pk_bf16_f32 v252, -v145, -v147
    v_cvt_pk_bf16_f32 v245, v148, v150
    v_cvt_pk_bf16_f32 v253, -v149, -v151
    v_cvt_pk_bf16_f32 v246, v152, v154
    v_cvt_pk_bf16_f32 v254, -v153, -v155
    v_cvt_pk_bf16_f32 v247, v156, v158
    v_cvt_pk_bf16_f32 v255, -v157, -v159
    ds_write_b128 v7, v[240:243] offset:4096
    ds_write_b128 v7, v[244:247] offset:4112
    ds_write_b128 v7, v[248:251] offset:6144
    ds_write_b128 v7, v[252:255] offset:6160
    ds_read_b64_tr_b16 v[96:97], v8 offset:0
    ds_read_b64_tr_b16 v[98:99], v8 offset:256
    ds_read_b64_tr_b16 v[100:101], v8 offset:1024
    ds_read_b64_tr_b16 v[102:103], v8 offset:1280
    ds_read_b64_tr_b16 v[104:105], v8 offset:2048
    ds_read_b64_tr_b16 v[106:107], v8 offset:2304
    ds_read_b64_tr_b16 v[108:109], v8 offset:3072
    ds_read_b64_tr_b16 v[110:111], v8 offset:3328
    s_waitcnt lgkmcnt(6)
    buffer_store_dwordx4 v[96:99], v19, s[52:55], s84 offen offset:0 sc1
    s_waitcnt lgkmcnt(4)
    buffer_store_dwordx4 v[100:103], v19, s[52:55], s84 offen offset:1024 sc1
    s_waitcnt lgkmcnt(2)
    buffer_store_dwordx4 v[104:107], v19, s[52:55], s84 offen offset:2048 sc1
    s_waitcnt lgkmcnt(0)
    buffer_store_dwordx4 v[108:111], v19, s[52:55], s84 offen offset:3072 sc1
    ds_read_b64_tr_b16 v[112:113], v8 offset:4096
    ds_read_b64_tr_b16 v[114:115], v8 offset:4352
    ds_read_b64_tr_b16 v[116:117], v8 offset:5120
    ds_read_b64_tr_b16 v[118:119], v8 offset:5376
    ds_read_b64_tr_b16 v[120:121], v8 offset:6144
    ds_read_b64_tr_b16 v[122:123], v8 offset:6400
    ds_read_b64_tr_b16 v[124:125], v8 offset:7168
    ds_read_b64_tr_b16 v[126:127], v8 offset:7424
    s_waitcnt lgkmcnt(6)
    buffer_store_dwordx4 v[112:115], v19, s[56:59], s84 offen offset:0 sc1
    s_waitcnt lgkmcnt(4)
    buffer_store_dwordx4 v[116:119], v19, s[56:59], s84 offen offset:1024 sc1
    s_waitcnt lgkmcnt(2)
    buffer_store_dwordx4 v[120:123], v19, s[56:59], s84 offen offset:2048 sc1
    s_waitcnt lgkmcnt(0)
    buffer_store_dwordx4 v[124:127], v19, s[56:59], s84 offen offset:3072 sc1
    s_branch L_p1_fin
L_p1_role1:
    s_waitcnt vmcnt(18)
    s_barrier
    ds_read_b128 a[0:3], v19 offset:0
    ds_read_b128 a[128:131], v19 offset:4096
    ds_read_b64_tr_b16 v[96:97], v18 offset:0
    ds_read_b64_tr_b16 v[98:99], v18 offset:256
    ds_read_b64_tr_b16 v[100:101], v18 offset:4096
    ds_read_b64_tr_b16 v[102:103], v18 offset:4352
    ds_read_b128 a[4:7], v20 offset:0
    ds_read_b128 a[132:135], v20 offset:4096
    ds_read_b64_tr_b16 v[104:105], v18 offset:1024
    ds_read_b64_tr_b16 v[106:107], v18 offset:1280
    ds_read_b64_tr_b16 v[108:109], v18 offset:5120
    ds_read_b64_tr_b16 v[110:111], v18 offset:5376
    ds_read_b128 a[8:11], v21 offset:0
    ds_read_b128 a[136:139], v21 offset:4096
    ds_read_b64_tr_b16 v[112:113], v18 offset:2048
    ds_read_b64_tr_b16 v[114:115], v18 offset:2304
    ds_read_b64_tr_b16 v[116:117], v18 offset:6144
    ds_read_b64_tr_b16 v[118:119], v18 offset:6400
    s_waitcnt lgkmcnt(14)
    v_mfma_f32_32x32x16_bf16 v[128:143], v[96:99], a[0:3], 0
    s_add_u32 s99, s76, s101
    s_add_u32 m0, s80, 32768
    s_nop 0
    buffer_load_dwordx4 v5, s[40:43], s99 offen offset:0 lds
    s_bitcmp1_b32 s5, 1
    s_cselect_b32 s48, s30, s28
    s_cselect_b32 s49, s31, s29
    s_mov_b32 s50, 1409024
    s_mov_b32 s51, 0x20000
    v_mfma_f32_32x32x16_bf16 v[160:175], v[96:99], a[128:131], 0
    buffer_load_dwordx4 v6, s[40:43], s99 offen offset:1024 lds
    s_lshl_b32 s79, s96, 6
    s_mul_i32 s83, s6, 88064
    s_add_u32 s79, s79, s83
    v_lshrrev_b32 v45, 3, v1
    s_movk_i32 s83, 2752
    s_waitcnt lgkmcnt(12)
    v_mfma_f32_32x32x16_bf16 v[144:159], v[100:103], a[0:3], 0
    buffer_load_dwordx4 v7, s[40:43], s99 offen offset:2048 lds
    v_mul_lo_u32 v45, v45, s83
    v_bfe_u32 v46, v1, 4, 1
    v_lshlrev_b32 v46, 2, v46
    v_and_b32 v44, 7, v1
    v_xor_b32 v46, v46, v44
    v_mfma_f32_32x32x16_bf16 v[176:191], v[100:103], a[128:131], 0
    buffer_load_dwordx4 v8, s[40:43], s99 offen offset:3072 lds
    v_lshl_add_u32 v9, v46, 4, v45
    v_add_u32 v10, 20992, v9
    v_add_u32 v11, 41984, v9
    v_add_u32 v12, 62976, v9
    s_add_u32 s60, s38, 13631488
    s_addc_u32 s61, s39, 0
    ds_read_b128 a[12:15], v22 offset:0
    ds_read_b128 a[140:143], v22 offset:4096
    ds_read_b64_tr_b16 v[120:121], v18 offset:3072
    ds_read_b64_tr_b16 v[122:123], v18 offset:3328
    ds_read_b64_tr_b16 v[124:125], v18 offset:7168
    ds_read_b64_tr_b16 v[126:127], v18 offset:7424
    s_waitcnt lgkmcnt(14)
    v_mfma_f32_32x32x16_bf16 v[128:143], v[104:107], a[4:7], v[128:143]
    s_mul_i32 s99, s101, s78
    s_add_u32 s99, s99, s77
    s_add_u32 m0, s80, 98304
    s_nop 0
    buffer_load_dwordx4 v13, s[44:47], s99 offen offset:0 lds
    s_mov_b32 s62, 458752
    s_mov_b32 s63, 0x20000
    s_lshl_b32 s81, s95, 11
    s_lshl_b32 s83, s97, 11
    s_cmp_eq_u32 s7, 0
    s_cselect_b32 s82, s82, s83
    v_mfma_f32_32x32x16_bf16 v[160:175], v[104:107], a[132:135], v[160:175]
    buffer_load_dwordx4 v14, s[44:47], s99 offen offset:1024 lds
    v_lshlrev_b32 v27, 4, v4
    v_lshl_add_u32 v27, v3, 9, v27
    v_bfe_u32 v44, v1, 2, 2
    s_waitcnt lgkmcnt(12)
    v_mfma_f32_32x32x16_bf16 v[144:159], v[108:111], a[4:7], v[144:159]
    buffer_load_dwordx4 v15, s[44:47], s99 offen offset:2048 lds
    v_lshl_add_u32 v44, v3, 3, v44
    v_lshlrev_b32 v44, 7, v44
    v_bfe_u32 v45, v1, 4, 1
    v_lshlrev_b32 v45, 1, v45
    v_bfe_u32 v46, v1, 1, 1
    v_mfma_f32_32x32x16_bf16 v[176:191], v[108:111], a[132:135], v[176:191]
    buffer_load_dwordx4 v16, s[44:47], s99 offen offset:3072 lds
    s_add_u32 s101, s101, 128
    s_and_b32 s101, s101, 1023
    v_add_u32 v45, v45, v46
    s_lshl_b32 s83, s7, 2
    v_add_u32 v45, s83, v45
    v_bfe_u32 v46, v1, 3, 1
    v_lshlrev_b32 v46, 2, v46
    s_waitcnt lgkmcnt(0)
    v_mfma_f32_32x32x16_bf16 v[128:143], v[112:115], a[8:11], v[128:143]
    s_waitcnt vmcnt(18)
    s_barrier
    ds_read_b128 a[16:19], v19 offset:16384
    ds_read_b128 a[144:147], v19 offset:20480
    ds_read_b64_tr_b16 v[96:97], v18 offset:16384
    ds_read_b64_tr_b16 v[98:99], v18 offset:16640
    ds_read_b64_tr_b16 v[100:101], v18 offset:20480
    ds_read_b64_tr_b16 v[102:103], v18 offset:20736
    s_add_u32 s99, s76, s101
    s_add_u32 m0, s80, 49152
    s_nop 0
    buffer_load_dwordx4 v5, s[40:43], s99 offen offset:0 lds
    v_xor_b32 v45, v45, v46
    v_lshl_add_u32 v44, v45, 4, v44
    v_and_b32 v45, 1, v1
    v_lshl_add_u32 v34, v45, 3, v44
    v_add_u32 v35, 65536, v34
    v_mfma_f32_32x32x16_bf16 v[160:175], v[112:115], a[136:139], v[160:175]
    buffer_load_dwordx4 v6, s[40:43], s99 offen offset:1024 lds
    s_lshl_b32 s83, s3, 2
    s_lshl_b32 s84, s6, 1
    s_add_u32 s83, s83, s84
    s_mul_i32 s83, s83, 153600
    s_add_u32 s52, s38, s83
    s_addc_u32 s53, s39, 0
    v_mfma_f32_32x32x16_bf16 v[144:159], v[116:119], a[8:11], v[144:159]
    buffer_load_dwordx4 v7, s[40:43], s99 offen offset:2048 lds
    s_add_u32 s56, s52, 153600
    s_addc_u32 s57, s53, 0
    s_mov_b32 s54, 153600
    s_mov_b32 s55, 0x20000
    v_mfma_f32_32x32x16_bf16 v[176:191], v[116:119], a[136:139], v[176:191]
    buffer_load_dwordx4 v8, s[40:43], s99 offen offset:3072 lds
    s_mov_b32 s58, 153600
    s_mov_b32 s59, 0x20000
    v_mov_b32 v38, 0
    v_mov_b32 v39, 0
    v_mov_b32 v42, 0
    ds_read_b128 a[20:23], v20 offset:16384
    ds_read_b128 a[148:151], v20 offset:20480
    ds_read_b64_tr_b16 v[104:105], v18 offset:17408
    ds_read_b64_tr_b16 v[106:107], v18 offset:17664
    ds_read_b64_tr_b16 v[108:109], v18 offset:21504
    ds_read_b64_tr_b16 v[110:111], v18 offset:21760
    v_mfma_f32_32x32x16_bf16 v[128:143], v[120:123], a[12:15], v[128:143]
    s_mul_i32 s99, s101, s78
    s_add_u32 s99, s99, s77
    s_add_u32 m0, s80, 114688
    s_nop 0
    buffer_load_dwordx4 v13, s[44:47], s99 offen offset:0 lds
    v_mov_b32 v43, 0
    v_mov_b32 v46, 0
    v_mov_b32 v47, 0
    v_mov_b32 v50, 0
    v_mov_b32 v51, 0
    v_mfma_f32_32x32x16_bf16 v[160:175], v[120:123], a[140:143], v[160:175]
    buffer_load_dwordx4 v14, s[44:47], s99 offen offset:1024 lds
    v_mov_b32 v72, 0
    v_mov_b32 v73, 0
    v_mov_b32 v74, 0
    v_mov_b32 v75, 0
    s_waitcnt vmcnt(23)
    v_lshlrev_b32 v76, 16, v64
    v_mfma_f32_32x32x16_bf16 v[144:159], v[124:127], a[12:15], v[144:159]
    buffer_load_dwordx4 v15, s[44:47], s99 offen offset:2048 lds
    v_and_b32 v77, s86, v64
    v_add_f32 v72, v72, v76
    v_fmac_f32 v73, v76, v76
    v_add_f32 v72, v72, v77
    v_fmac_f32 v73, v77, v77
    v_mfma_f32_32x32x16_bf16 v[176:191], v[124:127], a[140:143], v[176:191]
    buffer_load_dwordx4 v16, s[44:47], s99 offen offset:3072 lds
    s_add_u32 s101, s101, 128
    s_and_b32 s101, s101, 1023
    s_waitcnt vmcnt(24)
    v_lshlrev_b32 v78, 16, v68
    v_and_b32 v79, s86, v68
    v_add_f32 v74, v74, v78
    v_fmac_f32 v75, v78, v78
    v_add_f32 v74, v74, v79
    ds_read_b128 a[24:27], v21 offset:16384
    ds_read_b128 a[152:155], v21 offset:20480
    ds_read_b64_tr_b16 v[112:113], v18 offset:18432
    ds_read_b64_tr_b16 v[114:115], v18 offset:18688
    ds_read_b64_tr_b16 v[116:117], v18 offset:22528
    ds_read_b64_tr_b16 v[118:119], v18 offset:22784
    s_waitcnt lgkmcnt(14)
    v_mfma_f32_32x32x16_bf16 v[128:143], v[96:99], a[16:19], v[128:143]
    s_add_u32 s99, s76, s101
    s_add_u32 m0, s80, 0
    s_nop 0
    buffer_load_dwordx4 v5, s[40:43], s99 offen offset:0 lds
    v_fmac_f32 v75, v79, v79
    v_lshlrev_b32 v76, 16, v65
    v_and_b32 v77, s86, v65
    v_add_f32 v72, v72, v76
    v_fmac_f32 v73, v76, v76
    v_mfma_f32_32x32x16_bf16 v[160:175], v[96:99], a[144:147], v[160:175]
    buffer_load_dwordx4 v6, s[40:43], s99 offen offset:1024 lds
    v_add_f32 v72, v72, v77
    v_fmac_f32 v73, v77, v77
    v_lshlrev_b32 v78, 16, v69
    v_and_b32 v79, s86, v69
    v_add_f32 v74, v74, v78
    s_waitcnt lgkmcnt(12)
    v_mfma_f32_32x32x16_bf16 v[144:159], v[100:103], a[16:19], v[144:159]
    buffer_load_dwordx4 v7, s[40:43], s99 offen offset:2048 lds
    v_fmac_f32 v75, v78, v78
    v_add_f32 v74, v74, v79
    v_fmac_f32 v75, v79, v79
    v_lshlrev_b32 v76, 16, v66
    v_and_b32 v77, s86, v66
    v_mfma_f32_32x32x16_bf16 v[176:191], v[100:103], a[144:147], v[176:191]
    buffer_load_dwordx4 v8, s[40:43], s99 offen offset:3072 lds
    v_add_f32 v72, v72, v76
    v_fmac_f32 v73, v76, v76
    v_add_f32 v72, v72, v77
    v_fmac_f32 v73, v77, v77
    v_lshlrev_b32 v78, 16, v70
    ds_read_b128 a[28:31], v22 offset:16384
    ds_read_b128 a[156:159], v22 offset:20480
    ds_read_b64_tr_b16 v[120:121], v18 offset:19456
    ds_read_b64_tr_b16 v[122:123], v18 offset:19712
    ds_read_b64_tr_b16 v[124:125], v18 offset:23552
    ds_read_b64_tr_b16 v[126:127], v18 offset:23808
    s_waitcnt lgkmcnt(14)
    v_mfma_f32_32x32x16_bf16 v[128:143], v[104:107], a[20:23], v[128:143]
    s_mul_i32 s99, s101, s78
    s_add_u32 s99, s99, s77
    s_add_u32 m0, s80, 65536
    s_nop 0
    buffer_load_dwordx4 v13, s[44:47], s99 offen offset:0 lds
    v_and_b32 v79, s86, v70
    v_add_f32 v74, v74, v78
    v_fmac_f32 v75, v78, v78
    v_add_f32 v74, v74, v79
    v_fmac_f32 v75, v79, v79
    v_mfma_f32_32x32x16_bf16 v[160:175], v[104:107], a[148:151], v[160:175]
    buffer_load_dwordx4 v14, s[44:47], s99 offen offset:1024 lds
    v_lshlrev_b32 v76, 16, v67
    v_and_b32 v77, s86, v67
    v_add_f32 v72, v72, v76
    v_fmac_f32 v73, v76, v76
    v_add_f32 v72, v72, v77
    s_waitcnt lgkmcnt(12)
    v_mfma_f32_32x32x16_bf16 v[144:159], v[108:111], a[20:23], v[144:159]
    buffer_load_dwordx4 v15, s[44:47], s99 offen offset:2048 lds
    v_fmac_f32 v73, v77, v77
    v_lshlrev_b32 v78, 16, v71
    v_and_b32 v79, s86, v71
    v_add_f32 v74, v74, v78
    v_fmac_f32 v75, v78, v78
    v_mfma_f32_32x32x16_bf16 v[176:191], v[108:111], a[148:151], v[176:191]
    buffer_load_dwordx4 v16, s[44:47], s99 offen offset:3072 lds
    s_add_u32 s101, s101, 128
    s_and_b32 s101, s101, 1023
    v_add_f32 v74, v74, v79
    v_fmac_f32 v75, v79, v79
    v_add_f32_dpp v72, v72, v72 row_shr:1 bound_ctrl:0
    v_add_f32_dpp v73, v73, v73 row_shr:1 bound_ctrl:0
    v_add_f32_dpp v74, v74, v74 row_shr:1 bound_ctrl:0
    s_waitcnt lgkmcnt(0)
    v_mfma_f32_32x32x16_bf16 v[128:143], v[112:115], a[24:27], v[128:143]
    v_add_f32_dpp v75, v75, v75 row_shr:1 bound_ctrl:0
    v_add_f32_dpp v72, v72, v72 row_shr:2 bound_ctrl:0
    v_add_f32_dpp v73, v73, v73 row_shr:2 bound_ctrl:0
    v_add_f32_dpp v74, v74, v74 row_shr:2 bound_ctrl:0
    v_add_f32_dpp v75, v75, v75 row_shr:2 bound_ctrl:0
    v_add_f32_dpp v72, v72, v72 row_shr:4 bound_ctrl:0
    v_add_f32_dpp v73, v73, v73 row_shr:4 bound_ctrl:0
    v_add_f32_dpp v74, v74, v74 row_shr:4 bound_ctrl:0
    v_add_f32_dpp v75, v75, v75 row_shr:4 bound_ctrl:0
    v_add_f32_dpp v72, v72, v72 row_shr:8 bound_ctrl:0
    v_add_f32_dpp v73, v73, v73 row_shr:8 bound_ctrl:0
    v_add_f32_dpp v74, v74, v74 row_shr:8 bound_ctrl:0
    v_add_f32_dpp v75, v75, v75 row_shr:8 bound_ctrl:0
    v_add_f32_dpp v72, v72, v72 row_bcast:15 row_mask:0xa
    v_add_f32_dpp v73, v73, v73 row_bcast:15 row_mask:0xa
    v_add_f32_dpp v74, v74, v74 row_bcast:15 row_mask:0xa
    v_add_f32_dpp v75, v75, v75 row_bcast:15 row_mask:0xa
    v_add_f32_dpp v72, v72, v72 row_bcast:31 row_mask:0xc
    v_add_f32_dpp v73, v73, v73 row_bcast:31 row_mask:0xc
    v_add_f32_dpp v74, v74, v74 row_bcast:31 row_mask:0xc
    v_add_f32_dpp v75, v75, v75 row_bcast:31 row_mask:0xc
    v_mul_f32 v72, 0x3b000000, v72
    v_mul_f32 v74, 0x3b000000, v74
    v_mul_f32 v73, 0x3b000000, v73
    v_mul_f32 v75, 0x3b000000, v75
    v_fma_f32 v73, -v72, v72, v73
    v_fma_f32 v75, -v74, v74, v75
    v_max_f32 v73, 0, v73
    v_max_f32 v75, 0, v75
    v_cvt_pk_bf16_f32 v76, v72, v72
    v_cvt_pk_bf16_f32 v77, v74, v74
    v_lshlrev_b32 v72, 16, v76
    v_lshlrev_b32 v74, 16, v77
    v_cvt_pk_bf16_f32 v76, v73, v73
    v_cvt_pk_bf16_f32 v77, v75, v75
    v_lshlrev_b32 v73, 16, v76
    v_lshlrev_b32 v75, 16, v77
    v_add_f32 v73, 0x3727c5ac, v73
    v_add_f32 v75, 0x3727c5ac, v75
    v_cvt_pk_bf16_f32 v76, v73, v73
    v_cvt_pk_bf16_f32 v77, v75, v75
    v_lshlrev_b32 v73, 16, v76
    v_lshlrev_b32 v75, 16, v77
    v_sqrt_f32 v73, v73
    v_sqrt_f32 v75, v75
    v_cvt_pk_bf16_f32 v76, v73, v73
    v_cvt_pk_bf16_f32 v77, v75, v75
    v_lshlrev_b32 v73, 16, v76
    v_lshlrev_b32 v75, 16, v77
    v_rcp_f32 v73, v73
    v_rcp_f32 v75, v75
    s_nop 0
    v_mov_b32 v78, v75
    v_mov_b32 v76, v74
    v_mov_b32 v74, v73
    s_waitcnt vmcnt(28)
    v_mov_b32 v80, 0x3f803f80
    v_mov_b32 v81, v80
    v_mov_b32 v82, v80
    v_mov_b32 v83, v80
    s_add_u32 s92, s80, 131072
    s_cmp_lt_u32 s3, 4
    s_cbranch_scc0 L_p1_c1ffn1
    v_add_u32 v84, s92, v84
    ds_read_b128 v[192:195], v84
    v_add_u32 v85, s92, v85
    ds_read_b128 v[196:199], v85
    v_add_u32 v86, s92, v86
    ds_read_b128 v[200:203], v86
    v_add_u32 v87, s92, v87
    ds_read_b128 v[204:207], v87
    s_branch L_p1_c1done1
L_p1_c1ffn1:
    v_add_u32 v84, s92, v17
    s_waitcnt lgkmcnt(3)
    ds_read_b64_tr_b16 v[192:193], v84 offset:0
    ds_read_b64_tr_b16 v[194:195], v84 offset:256
    s_waitcnt lgkmcnt(4)
    ds_read_b64_tr_b16 v[196:197], v84 offset:1024
    ds_read_b64_tr_b16 v[198:199], v84 offset:1280
    s_waitcnt lgkmcnt(5)
    ds_read_b64_tr_b16 v[200:201], v84 offset:2048
    ds_read_b64_tr_b16 v[202:203], v84 offset:2304
    s_waitcnt lgkmcnt(6)
    ds_read_b64_tr_b16 v[204:205], v84 offset:3072
    ds_read_b64_tr_b16 v[206:207], v84 offset:3328
L_p1_c1done1:
    s_waitcnt lgkmcnt(0)
    v_mfma_f32_32x32x16_bf16 v[224:239], v[80:83], v[192:195], 0
    v_mfma_f32_32x32x16_bf16 v[224:239], v[80:83], v[196:199], v[224:239]
    v_mfma_f32_32x32x16_bf16 v[224:239], v[80:83], v[200:203], v[224:239]
    v_mfma_f32_32x32x16_bf16 v[224:239], v[80:83], v[204:207], v[224:239]
    s_waitcnt vmcnt(16)
    s_barrier
    ds_read_b128 a[32:35], v19 offset:32768
    ds_read_b128 a[160:163], v19 offset:36864
    ds_read_b64_tr_b16 v[96:97], v18 offset:32768
    ds_read_b64_tr_b16 v[98:99], v18 offset:33024
    ds_read_b64_tr_b16 v[100:101], v18 offset:36864
    ds_read_b64_tr_b16 v[102:103], v18 offset:37120
    s_add_u32 s99, s76, s101
    s_add_u32 m0, s80, 16384
    s_nop 0
    buffer_load_dwordx4 v5, s[40:43], s99 offen offset:0 lds
    s_lshl_b32 s92, s5, 7
    v_lshlrev_b32 v84, 2, v2
    v_add_u32 v84, s92, v84
    v_add_u32 v84, 150016, v84
    ds_write_b32 v84, v224
    v_mfma_f32_32x32x16_bf16 v[160:175], v[112:115], a[152:155], v[160:175]
    buffer_load_dwordx4 v6, s[40:43], s99 offen offset:1024 lds
    v_mfma_f32_32x32x16_bf16 v[144:159], v[116:119], a[24:27], v[144:159]
    buffer_load_dwordx4 v7, s[40:43], s99 offen offset:2048 lds
    v_mfma_f32_32x32x16_bf16 v[176:191], v[116:119], a[152:155], v[176:191]
    buffer_load_dwordx4 v8, s[40:43], s99 offen offset:3072 lds
    ds_read_b128 a[36:39], v20 offset:32768
    ds_read_b128 a[164:167], v20 offset:36864
    ds_read_b64_tr_b16 v[104:105], v18 offset:33792
    ds_read_b64_tr_b16 v[106:107], v18 offset:34048
    ds_read_b64_tr_b16 v[108:109], v18 offset:37888
    ds_read_b64_tr_b16 v[110:111], v18 offset:38144
    v_mfma_f32_32x32x16_bf16 v[128:143], v[120:123], a[28:31], v[128:143]
    s_mul_i32 s99, s101, s78
    s_add_u32 s99, s99, s77
    s_add_u32 m0, s80, 81920
    s_nop 0
    buffer_load_dwordx4 v13, s[44:47], s99 offen offset:0 lds
    v_mfma_f32_32x32x16_bf16 v[160:175], v[120:123], a[156:159], v[160:175]
    buffer_load_dwordx4 v14, s[44:47], s99 offen offset:1024 lds
    v_mfma_f32_32x32x16_bf16 v[144:159], v[124:127], a[28:31], v[144:159]
    buffer_load_dwordx4 v15, s[44:47], s99 offen offset:2048 lds
    v_mfma_f32_32x32x16_bf16 v[176:191], v[124:127], a[156:159], v[176:191]
    buffer_load_dwordx4 v16, s[44:47], s99 offen offset:3072 lds
    s_add_u32 s101, s101, 128
    s_and_b32 s101, s101, 1023
    ds_read_b128 a[40:43], v21 offset:32768
    ds_read_b128 a[168:171], v21 offset:36864
    ds_read_b64_tr_b16 v[112:113], v18 offset:34816
    ds_read_b64_tr_b16 v[114:115], v18 offset:35072
    ds_read_b64_tr_b16 v[116:117], v18 offset:38912
    ds_read_b64_tr_b16 v[118:119], v18 offset:39168
    s_waitcnt lgkmcnt(15)
    v_mfma_f32_32x32x16_bf16 v[128:143], v[96:99], a[32:35], v[128:143]
    v_mfma_f32_32x32x16_bf16 v[160:175], v[96:99], a[160:163], v[160:175]
    s_waitcnt lgkmcnt(13)
    v_mfma_f32_32x32x16_bf16 v[144:159], v[100:103], a[32:35], v[144:159]
    v_mfma_f32_32x32x16_bf16 v[176:191], v[100:103], a[160:163], v[176:191]
    ds_read_b128 a[44:47], v22 offset:32768
    ds_read_b128 a[172:175], v22 offset:36864
    ds_read_b64_tr_b16 v[120:121], v18 offset:35840
    ds_read_b64_tr_b16 v[122:123], v18 offset:36096
    ds_read_b64_tr_b16 v[124:125], v18 offset:39936
    ds_read_b64_tr_b16 v[126:127], v18 offset:40192
    s_waitcnt lgkmcnt(14)
    v_mfma_f32_32x32x16_bf16 v[128:143], v[104:107], a[36:39], v[128:143]
    v_mfma_f32_32x32x16_bf16 v[160:175], v[104:107], a[164:167], v[160:175]
    s_waitcnt lgkmcnt(12)
    v_mfma_f32_32x32x16_bf16 v[144:159], v[108:111], a[36:39], v[144:159]
    v_mfma_f32_32x32x16_bf16 v[176:191], v[108:111], a[164:167], v[176:191]
    s_waitcnt lgkmcnt(0)
    v_mfma_f32_32x32x16_bf16 v[128:143], v[112:115], a[40:43], v[128:143]
    s_waitcnt vmcnt(16)
    s_barrier
    ds_read_b128 a[48:51], v19 offset:49152
    ds_read_b128 a[176:179], v19 offset:53248
    ds_read_b64_tr_b16 v[96:97], v18 offset:49152
    ds_read_b64_tr_b16 v[98:99], v18 offset:49408
    ds_read_b64_tr_b16 v[100:101], v18 offset:53248
    ds_read_b64_tr_b16 v[102:103], v18 offset:53504
    s_add_u32 s99, s76, s101
    s_add_u32 m0, s80, 32768
    s_nop 0
    buffer_load_dwordx4 v5, s[40:43], s99 offen offset:0 lds
    v_mov_b32 v92, 150528
    ds_read_b32 v91, v92
    v_lshlrev_b32 v93, 2, v2
    v_add_u32 v93, 150016, v93
    ds_read2_b32 v[84:85], v93 offset0:0 offset1:32
    v_mfma_f32_32x32x16_bf16 v[160:175], v[112:115], a[168:171], v[160:175]
    buffer_load_dwordx4 v6, s[40:43], s99 offen offset:1024 lds
    ds_read2_b32 v[86:87], v93 offset0:64 offset1:96
    s_waitcnt lgkmcnt(2)
    v_readfirstlane_b32 s85, v91
    v_mov_b32 v73, v91
    v_mov_b32 v75, v91
    v_mov_b32 v77, v91
    v_mfma_f32_32x32x16_bf16 v[144:159], v[116:119], a[40:43], v[144:159]
    buffer_load_dwordx4 v7, s[40:43], s99 offen offset:2048 lds
    v_mov_b32 v79, v91
    s_lshl_b32 s92, s3, 11
    s_lshl_b32 s93, s4, 7
    s_add_u32 s92, s92, s93
    s_lshl_b32 s93, s5, 5
    v_mfma_f32_32x32x16_bf16 v[176:191], v[116:119], a[168:171], v[176:191]
    buffer_load_dwordx4 v8, s[40:43], s99 offen offset:3072 lds
    s_add_u32 s92, s92, s93
    s_mov_b32 exec_lo, 0
    s_mov_b32 exec_hi, 0x80000000
    buffer_store_dwordx4 v[72:75], off, s[60:63], s92 sc1
    buffer_store_dwordx4 v[76:79], off, s[60:63], s92 offset:16 sc1
    s_mov_b64 exec, -1
    ds_read_b128 a[52:55], v20 offset:49152
    ds_read_b128 a[180:183], v20 offset:53248
    ds_read_b64_tr_b16 v[104:105], v18 offset:50176
    ds_read_b64_tr_b16 v[106:107], v18 offset:50432
    ds_read_b64_tr_b16 v[108:109], v18 offset:54272
    ds_read_b64_tr_b16 v[110:111], v18 offset:54528
    v_mfma_f32_32x32x16_bf16 v[128:143], v[120:123], a[44:47], v[128:143]
    s_mul_i32 s99, s101, s78
    s_add_u32 s99, s99, s77
    s_add_u32 m0, s80, 98304
    s_nop 0
    buffer_load_dwordx4 v13, s[44:47], s99 offen offset:0 lds
    s_waitcnt lgkmcnt(7)
    v_add_f32 v84, v84, v85
    s_waitcnt lgkmcnt(6)
    v_add_f32 v86, v86, v87
    v_add_f32 v84, v84, v86
    v_mov_b32 v85, v91
    v_mfma_f32_32x32x16_bf16 v[160:175], v[120:123], a[172:175], v[160:175]
    buffer_load_dwordx4 v14, s[44:47], s99 offen offset:1024 lds
    s_lshl_b32 s92, s4, 3
    s_lshr_b32 s93, s3, 1
    s_add_u32 s92, s92, s93
    s_lshl_b32 s92, s92, 9
    s_and_b32 s93, s3, 1
    v_mfma_f32_32x32x16_bf16 v[144:159], v[124:127], a[44:47], v[144:159]
    buffer_load_dwordx4 v15, s[44:47], s99 offen offset:2048 lds
    s_lshl_b32 s93, s93, 3
    s_add_u32 s92, s92, s93
    s_add_u32 s92, s92, 196608
    v_lshlrev_b32 v93, 4, v2
    s_cmp_eq_u32 s5, 0
    s_cselect_b32 exec_lo, -1, 0
    s_mov_b32 exec_hi, 0
    buffer_store_dwordx2 v[84:85], v93, s[60:63], s92 offen sc1
    s_mov_b64 exec, -1
    v_mfma_f32_32x32x16_bf16 v[176:191], v[124:127], a[172:175], v[176:191]
    buffer_load_dwordx4 v16, s[44:47], s99 offen offset:3072 lds
    s_add_u32 s101, s101, 128
    s_and_b32 s101, s101, 1023
    s_lshl_b32 s68, s3, 11
    ds_read_b128 a[56:59], v21 offset:49152
    ds_read_b128 a[184:187], v21 offset:53248
    ds_read_b64_tr_b16 v[112:113], v18 offset:51200
    ds_read_b64_tr_b16 v[114:115], v18 offset:51456
    ds_read_b64_tr_b16 v[116:117], v18 offset:55296
    ds_read_b64_tr_b16 v[118:119], v18 offset:55552
    v_mfma_f32_32x32x16_bf16 v[128:143], v[96:99], a[48:51], v[128:143]
    s_lshl_b32 s69, s6, 10
    s_add_u32 s68, s68, s69
    v_lshlrev_b32 v64, 4, v4
    s_lshl_b32 s69, s4, 12
    s_add_u32 s69, s69, 197632
    v_mfma_f32_32x32x16_bf16 v[160:175], v[96:99], a[176:179], v[160:175]
    v_lshlrev_b32 v65, 4, v2
    v_mfma_f32_32x32x16_bf16 v[144:159], v[100:103], a[48:51], v[144:159]
    v_mfma_f32_32x32x16_bf16 v[176:191], v[100:103], a[176:179], v[176:191]
    ds_read_b128 a[60:63], v22 offset:49152
    ds_read_b128 a[188:191], v22 offset:53248
    ds_read_b64_tr_b16 v[120:121], v18 offset:52224
    ds_read_b64_tr_b16 v[122:123], v18 offset:52480
    ds_read_b64_tr_b16 v[124:125], v18 offset:56320
    ds_read_b64_tr_b16 v[126:127], v18 offset:56576
    s_waitcnt lgkmcnt(14)
    v_mfma_f32_32x32x16_bf16 v[128:143], v[104:107], a[52:55], v[128:143]
    v_mfma_f32_32x32x16_bf16 v[160:175], v[104:107], a[180:183], v[160:175]
    s_waitcnt lgkmcnt(12)
    v_mfma_f32_32x32x16_bf16 v[144:159], v[108:111], a[52:55], v[144:159]
    v_mfma_f32_32x32x16_bf16 v[176:191], v[108:111], a[180:183], v[176:191]
    s_waitcnt lgkmcnt(0)
    v_mfma_f32_32x32x16_bf16 v[128:143], v[112:115], a[56:59], v[128:143]
    s_waitcnt vmcnt(19)
    s_barrier
    ds_read_b128 a[64:67], v19 offset:0
    ds_read_b128 a[192:195], v19 offset:4096
    ds_read_b64_tr_b16 v[96:97], v18 offset:0
    ds_read_b64_tr_b16 v[98:99], v18 offset:256
    ds_read_b64_tr_b16 v[100:101], v18 offset:4096
    ds_read_b64_tr_b16 v[102:103], v18 offset:4352
    s_add_u32 s99, s76, s101
    s_add_u32 m0, s80, 49152
    s_nop 0
    buffer_load_dwordx4 v5, s[40:43], s99 offen offset:0 lds
    v_mfma_f32_32x32x16_bf16 v[160:175], v[112:115], a[184:187], v[160:175]
    buffer_load_dwordx4 v6, s[40:43], s99 offen offset:1024 lds
    v_mfma_f32_32x32x16_bf16 v[144:159], v[116:119], a[56:59], v[144:159]
    buffer_load_dwordx4 v7, s[40:43], s99 offen offset:2048 lds
    v_mfma_f32_32x32x16_bf16 v[176:191], v[116:119], a[184:187], v[176:191]
    buffer_load_dwordx4 v8, s[40:43], s99 offen offset:3072 lds
    ds_read_b128 a[68:71], v20 offset:0
    ds_read_b128 a[196:199], v20 offset:4096
    ds_read_b64_tr_b16 v[104:105], v18 offset:1024
    ds_read_b64_tr_b16 v[106:107], v18 offset:1280
    ds_read_b64_tr_b16 v[108:109], v18 offset:5120
    ds_read_b64_tr_b16 v[110:111], v18 offset:5376
    v_mfma_f32_32x32x16_bf16 v[128:143], v[120:123], a[60:63], v[128:143]
    s_mul_i32 s99, s101, s78
    s_add_u32 s99, s99, s77
    s_add_u32 m0, s80, 114688
    s_nop 0
    buffer_load_dwordx4 v13, s[44:47], s99 offen offset:0 lds
    v_mfma_f32_32x32x16_bf16 v[160:175], v[120:123], a[188:191], v[160:175]
    buffer_load_dwordx4 v14, s[44:47], s99 offen offset:1024 lds
    v_mfma_f32_32x32x16_bf16 v[144:159], v[124:127], a[60:63], v[144:159]
    buffer_load_dwordx4 v15, s[44:47], s99 offen offset:2048 lds
    v_mfma_f32_32x32x16_bf16 v[176:191], v[124:127], a[188:191], v[176:191]
    buffer_load_dwordx4 v16, s[44:47], s99 offen offset:3072 lds
    s_add_u32 s101, s101, 128
    s_and_b32 s101, s101, 1023
    ds_read_b128 a[72:75], v21 offset:0
    ds_read_b128 a[200:203], v21 offset:4096
    ds_read_b64_tr_b16 v[112:113], v18 offset:2048
    ds_read_b64_tr_b16 v[114:115], v18 offset:2304
    ds_read_b64_tr_b16 v[116:117], v18 offset:6144
    ds_read_b64_tr_b16 v[118:119], v18 offset:6400
    s_waitcnt lgkmcnt(14)
    v_mfma_f32_32x32x16_bf16 v[128:143], v[96:99], a[64:67], v[128:143]
    v_mfma_f32_32x32x16_bf16 v[160:175], v[96:99], a[192:195], v[160:175]
    s_waitcnt lgkmcnt(12)
    v_mfma_f32_32x32x16_bf16 v[144:159], v[100:103], a[64:67], v[144:159]
    v_mfma_f32_32x32x16_bf16 v[176:191], v[100:103], a[192:195], v[176:191]
    ds_read_b128 a[76:79], v22 offset:0
    ds_read_b128 a[204:207], v22 offset:4096
    ds_read_b64_tr_b16 v[120:121], v18 offset:3072
    ds_read_b64_tr_b16 v[122:123], v18 offset:3328
    ds_read_b64_tr_b16 v[124:125], v18 offset:7168
    ds_read_b64_tr_b16 v[126:127], v18 offset:7424
    s_waitcnt lgkmcnt(14)
    v_mfma_f32_32x32x16_bf16 v[128:143], v[104:107], a[68:71], v[128:143]
    v_mfma_f32_32x32x16_bf16 v[160:175], v[104:107], a[196:199], v[160:175]
    s_waitcnt lgkmcnt(12)
    v_mfma_f32_32x32x16_bf16 v[144:159], v[108:111], a[68:71], v[144:159]
    v_mfma_f32_32x32x16_bf16 v[176:191], v[108:111], a[196:199], v[176:191]
    s_waitcnt lgkmcnt(0)
    v_mfma_f32_32x32x16_bf16 v[128:143], v[112:115], a[72:75], v[128:143]
    s_waitcnt vmcnt(19)
    s_barrier
    ds_read_b128 a[80:83], v19 offset:16384
    ds_read_b128 a[208:211], v19 offset:20480
    ds_read_b64_tr_b16 v[96:97], v18 offset:16384
    ds_read_b64_tr_b16 v[98:99], v18 offset:16640
    ds_read_b64_tr_b16 v[100:101], v18 offset:20480
    ds_read_b64_tr_b16 v[102:103], v18 offset:20736
    s_mul_i32 s99, s100, 1376
    s_add_u32 s99, s99, s79
    s_add_u32 m0, s80, 0
    s_nop 0
    buffer_load_dwordx4 v9, s[48:51], s99 offen offset:0 lds
    buffer_load_dwordx4 v[208:211], v64, s[60:63], s68 offen sc1
    buffer_load_dwordx4 v[212:215], v64, s[60:63], s68 offen offset:512 sc1
    buffer_load_dwordx4 v[192:195], v65, s[60:63], s69 offen offset:0 sc1
    buffer_load_dwordx4 v[196:199], v65, s[60:63], s69 offen offset:512 sc1
    buffer_load_dwordx4 v[200:203], v65, s[60:63], s69 offen offset:2048 sc1
    v_mfma_f32_32x32x16_bf16 v[160:175], v[112:115], a[200:203], v[160:175]
    buffer_load_dwordx4 v[204:207], v65, s[60:63], s69 offen offset:2560 sc1
    v_mfma_f32_32x32x16_bf16 v[144:159], v[116:119], a[72:75], v[144:159]
    v_mfma_f32_32x32x16_bf16 v[176:191], v[116:119], a[200:203], v[176:191]
    buffer_load_dwordx4 v10, s[48:51], s99 offen offset:1024 lds
    ds_read_b128 a[84:87], v20 offset:16384
    ds_read_b128 a[212:215], v20 offset:20480
    ds_read_b64_tr_b16 v[104:105], v18 offset:17408
    ds_read_b64_tr_b16 v[106:107], v18 offset:17664
    ds_read_b64_tr_b16 v[108:109], v18 offset:21504
    ds_read_b64_tr_b16 v[110:111], v18 offset:21760
    v_mfma_f32_32x32x16_bf16 v[128:143], v[120:123], a[76:79], v[128:143]
    v_mfma_f32_32x32x16_bf16 v[160:175], v[120:123], a[204:207], v[160:175]
    v_mfma_f32_32x32x16_bf16 v[144:159], v[124:127], a[76:79], v[144:159]
    buffer_load_dwordx4 v11, s[48:51], s99 offen offset:2048 lds
    v_mfma_f32_32x32x16_bf16 v[176:191], v[124:127], a[204:207], v[176:191]
    ds_read_b128 a[88:91], v21 offset:16384
    ds_read_b128 a[216:219], v21 offset:20480
    ds_read_b64_tr_b16 v[112:113], v18 offset:18432
    ds_read_b64_tr_b16 v[114:115], v18 offset:18688
    ds_read_b64_tr_b16 v[116:117], v18 offset:22528
    ds_read_b64_tr_b16 v[118:119], v18 offset:22784
    s_waitcnt lgkmcnt(14)
    v_mfma_f32_32x32x16_bf16 v[128:143], v[96:99], a[80:83], v[128:143]
    v_mfma_f32_32x32x16_bf16 v[160:175], v[96:99], a[208:211], v[160:175]
    buffer_load_dwordx4 v12, s[48:51], s99 offen offset:3072 lds
    s_add_u32 s100, s100, 128
    s_and_b32 s100, s100, 1023
    s_waitcnt lgkmcnt(12)
    v_mfma_f32_32x32x16_bf16 v[144:159], v[100:103], a[80:83], v[144:159]
    v_mfma_f32_32x32x16_bf16 v[176:191], v[100:103], a[208:211], v[176:191]
    ds_read_b128 a[92:95], v22 offset:16384
    ds_read_b128 a[220:223], v22 offset:20480
    ds_read_b64_tr_b16 v[120:121], v18 offset:19456
    ds_read_b64_tr_b16 v[122:123], v18 offset:19712
    ds_read_b64_tr_b16 v[124:125], v18 offset:23552
    ds_read_b64_tr_b16 v[126:127], v18 offset:23808
    s_waitcnt lgkmcnt(14)
    v_mfma_f32_32x32x16_bf16 v[128:143], v[104:107], a[84:87], v[128:143]
    v_mfma_f32_32x32x16_bf16 v[160:175], v[104:107], a[212:215], v[160:175]
    s_waitcnt lgkmcnt(12)
    v_mfma_f32_32x32x16_bf16 v[144:159], v[108:111], a[84:87], v[144:159]
    v_mfma_f32_32x32x16_bf16 v[176:191], v[108:111], a[212:215], v[176:191]
    s_waitcnt lgkmcnt(0)
    v_mfma_f32_32x32x16_bf16 v[128:143], v[112:115], a[88:91], v[128:143]
    s_waitcnt vmcnt(18)
    s_barrier
    ds_read_b128 a[96:99], v19 offset:32768
    ds_read_b128 a[224:227], v19 offset:36864
    ds_read_b64_tr_b16 v[96:97], v18 offset:32768
    ds_read_b64_tr_b16 v[98:99], v18 offset:33024
    ds_read_b64_tr_b16 v[100:101], v18 offset:36864
    ds_read_b64_tr_b16 v[102:103], v18 offset:37120
    s_mul_i32 s99, s100, 1376
    s_add_u32 s99, s99, s79
    s_add_u32 m0, s80, 65536
    s_nop 0
    buffer_load_dwordx4 v9, s[48:51], s99 offen offset:0 lds
    v_mfma_f32_32x32x16_bf16 v[160:175], v[112:115], a[216:219], v[160:175]
    v_mfma_f32_32x32x16_bf16 v[144:159], v[116:119], a[88:91], v[144:159]
    v_mfma_f32_32x32x16_bf16 v[176:191], v[116:119], a[216:219], v[176:191]
    buffer_load_dwordx4 v10, s[48:51], s99 offen offset:1024 lds
    ds_read_b128 a[100:103], v20 offset:32768
    ds_read_b128 a[228:231], v20 offset:36864
    ds_read_b64_tr_b16 v[104:105], v18 offset:33792
    ds_read_b64_tr_b16 v[106:107], v18 offset:34048
    ds_read_b64_tr_b16 v[108:109], v18 offset:37888
    ds_read_b64_tr_b16 v[110:111], v18 offset:38144
    v_mfma_f32_32x32x16_bf16 v[128:143], v[120:123], a[92:95], v[128:143]
    v_mfma_f32_32x32x16_bf16 v[160:175], v[120:123], a[220:223], v[160:175]
    v_mfma_f32_32x32x16_bf16 v[144:159], v[124:127], a[92:95], v[144:159]
    buffer_load_dwordx4 v11, s[48:51], s99 offen offset:2048 lds
    v_mfma_f32_32x32x16_bf16 v[176:191], v[124:127], a[220:223], v[176:191]
    ds_read_b128 a[104:107], v21 offset:32768
    ds_read_b128 a[232:235], v21 offset:36864
    ds_read_b64_tr_b16 v[112:113], v18 offset:34816
    ds_read_b64_tr_b16 v[114:115], v18 offset:35072
    ds_read_b64_tr_b16 v[116:117], v18 offset:38912
    ds_read_b64_tr_b16 v[118:119], v18 offset:39168
    s_waitcnt lgkmcnt(14)
    v_mfma_f32_32x32x16_bf16 v[128:143], v[96:99], a[96:99], v[128:143]
    v_mfma_f32_32x32x16_bf16 v[160:175], v[96:99], a[224:227], v[160:175]
    buffer_load_dwordx4 v12, s[48:51], s99 offen offset:3072 lds
    s_add_u32 s100, s100, 128
    s_and_b32 s100, s100, 1023
    s_waitcnt lgkmcnt(12)
    v_mfma_f32_32x32x16_bf16 v[144:159], v[100:103], a[96:99], v[144:159]
    v_mfma_f32_32x32x16_bf16 v[176:191], v[100:103], a[224:227], v[176:191]
    ds_read_b128 a[108:111], v22 offset:32768
    ds_read_b128 a[236:239], v22 offset:36864
    ds_read_b64_tr_b16 v[120:121], v18 offset:35840
    ds_read_b64_tr_b16 v[122:123], v18 offset:36096
    ds_read_b64_tr_b16 v[124:125], v18 offset:39936
    ds_read_b64_tr_b16 v[126:127], v18 offset:40192
    s_waitcnt lgkmcnt(14)
    v_mfma_f32_32x32x16_bf16 v[128:143], v[104:107], a[100:103], v[128:143]
    v_mfma_f32_32x32x16_bf16 v[160:175], v[104:107], a[228:231], v[160:175]
    s_waitcnt lgkmcnt(12)
    v_mfma_f32_32x32x16_bf16 v[144:159], v[108:111], a[100:103], v[144:159]
    v_mfma_f32_32x32x16_bf16 v[176:191], v[108:111], a[228:231], v[176:191]
    s_waitcnt lgkmcnt(0)
    v_mfma_f32_32x32x16_bf16 v[128:143], v[112:115], a[104:107], v[128:143]
    s_waitcnt vmcnt(14)
    s_barrier
    ds_read_b128 a[112:115], v19 offset:49152
    ds_read_b128 a[240:243], v19 offset:53248
    ds_read_b64_tr_b16 v[96:97], v18 offset:49152
    ds_read_b64_tr_b16 v[98:99], v18 offset:49408
    ds_read_b64_tr_b16 v[100:101], v18 offset:53248
    ds_read_b64_tr_b16 v[102:103], v18 offset:53504
    s_mul_i32 s99, s100, 1376
    s_add_u32 s99, s99, s79
    s_add_u32 m0, s80, 16384
    s_nop 0
    buffer_load_dwordx4 v9, s[48:51], s99 offen offset:0 lds
    v_mfma_f32_32x32x16_bf16 v[160:175], v[112:115], a[232:235], v[160:175]
    v_mfma_f32_32x32x16_bf16 v[144:159], v[116:119], a[104:107], v[144:159]
    v_mfma_f32_32x32x16_bf16 v[176:191], v[116:119], a[232:235], v[176:191]
    buffer_load_dwordx4 v10, s[48:51], s99 offen offset:1024 lds
    ds_read_b128 a[116:119], v20 offset:49152
    ds_read_b128 a[244:247], v20 offset:53248
    ds_read_b64_tr_b16 v[104:105], v18 offset:50176
    ds_read_b64_tr_b16 v[106:107], v18 offset:50432
    ds_read_b64_tr_b16 v[108:109], v18 offset:54272
    ds_read_b64_tr_b16 v[110:111], v18 offset:54528
    v_mfma_f32_32x32x16_bf16 v[128:143], v[120:123], a[108:111], v[128:143]
    v_mfma_f32_32x32x16_bf16 v[160:175], v[120:123], a[236:239], v[160:175]
    v_mfma_f32_32x32x16_bf16 v[144:159], v[124:127], a[108:111], v[144:159]
    buffer_load_dwordx4 v11, s[48:51], s99 offen offset:2048 lds
    v_mfma_f32_32x32x16_bf16 v[176:191], v[124:127], a[236:239], v[176:191]
    ds_read_b128 a[120:123], v21 offset:49152
    ds_read_b128 a[248:251], v21 offset:53248
    ds_read_b64_tr_b16 v[112:113], v18 offset:51200
    ds_read_b64_tr_b16 v[114:115], v18 offset:51456
    ds_read_b64_tr_b16 v[116:117], v18 offset:55296
    ds_read_b64_tr_b16 v[118:119], v18 offset:55552
    s_waitcnt lgkmcnt(14)
    v_mfma_f32_32x32x16_bf16 v[128:143], v[96:99], a[112:115], v[128:143]
    v_mfma_f32_32x32x16_bf16 v[160:175], v[96:99], a[240:243], v[160:175]
    buffer_load_dwordx4 v12, s[48:51], s99 offen offset:3072 lds
    s_add_u32 s100, s100, 128
    s_and_b32 s100, s100, 1023
    s_waitcnt lgkmcnt(12)
    v_mfma_f32_32x32x16_bf16 v[144:159], v[100:103], a[112:115], v[144:159]
    v_mfma_f32_32x32x16_bf16 v[176:191], v[100:103], a[240:243], v[176:191]
    ds_read_b128 a[124:127], v22 offset:49152
    ds_read_b128 a[252:255], v22 offset:53248
    ds_read_b64_tr_b16 v[120:121], v18 offset:52224
    ds_read_b64_tr_b16 v[122:123], v18 offset:52480
    ds_read_b64_tr_b16 v[124:125], v18 offset:56320
    ds_read_b64_tr_b16 v[126:127], v18 offset:56576
    s_waitcnt lgkmcnt(14)
    v_mfma_f32_32x32x16_bf16 v[128:143], v[104:107], a[116:119], v[128:143]
    v_mfma_f32_32x32x16_bf16 v[160:175], v[104:107], a[244:247], v[160:175]
    s_waitcnt lgkmcnt(12)
    v_mfma_f32_32x32x16_bf16 v[144:159], v[108:111], a[116:119], v[144:159]
    v_mfma_f32_32x32x16_bf16 v[176:191], v[108:111], a[244:247], v[176:191]
    s_waitcnt lgkmcnt(0)
    v_mfma_f32_32x32x16_bf16 v[128:143], v[112:115], a[120:123], v[128:143]
    s_waitcnt vmcnt(11)
    v_mov_b32 v66, 0
    v_bitop3_b32 v66, v66, v193, s85 bitop3:0xf6
    v_bitop3_b32 v66, v66, v195, s85 bitop3:0xf6
    v_bitop3_b32 v66, v66, v197, s85 bitop3:0xf6
    v_bitop3_b32 v66, v66, v199, s85 bitop3:0xf6
    v_bitop3_b32 v66, v66, v201, s85 bitop3:0xf6
    v_bitop3_b32 v66, v66, v203, s85 bitop3:0xf6
    v_bitop3_b32 v66, v66, v205, s85 bitop3:0xf6
    v_bitop3_b32 v66, v66, v207, s85 bitop3:0xf6
    v_bitop3_b32 v66, v66, v209, s85 bitop3:0xf6
    v_bitop3_b32 v66, v66, v211, s85 bitop3:0xf6
    v_bitop3_b32 v66, v66, v213, s85 bitop3:0xf6
    v_bitop3_b32 v66, v66, v215, s85 bitop3:0xf6
    v_cmp_ne_u32 vcc, 0, v66
    s_cbranch_vccnz L_p1_ln1_slow
L_p1_ln1_ok:
    s_waitcnt vmcnt(8)
    s_barrier
    ds_read_b64_tr_b16 v[96:97], v34 offset:0
    ds_read_b64_tr_b16 v[98:99], v34 offset:512
    ds_read_b64_tr_b16 v[100:101], v34 offset:8192
    ds_read_b64_tr_b16 v[102:103], v34 offset:8704
    s_mul_i32 s99, s100, 1376
    s_add_u32 s99, s99, s79
    s_add_u32 m0, s80, 81920
    s_nop 0
    buffer_load_dwordx4 v9, s[48:51], s99 offen offset:0 lds
    v_mul_f32 v70, v210, v210
    v_mul_f32 v28, 0xc0135761, v210
    v_mul_f32 v71, v70, v210
    v_rcp_f32 v32, v70
    v_mul_f32 v30, 0xbdd2d3e8, v71
    v_mfma_f32_32x32x16_bf16 v[160:175], v[112:115], a[248:251], v[160:175]
    v_xor_b32 v70, 0x80000000, v208
    v_cndmask_b32 v70, v70, 0, s[88:89]
    v_lshrrev_b32 v37, 16, v70
    v_and_or_b32 v36, v70, s86, v37
    v_mul_f32 v70, v214, v214
    v_mfma_f32_32x32x16_bf16 v[144:159], v[116:119], a[120:123], v[144:159]
    v_mul_f32 v29, 0xc0135761, v214
    v_mul_f32 v71, v70, v214
    v_rcp_f32 v33, v70
    v_mul_f32 v31, 0xbdd2d3e8, v71
    v_xor_b32 v70, 0x80000000, v212
    v_mfma_f32_32x32x16_bf16 v[176:191], v[116:119], a[248:251], v[176:191]
    buffer_load_dwordx4 v10, s[48:51], s99 offen offset:1024 lds
    v_cndmask_b32 v70, v70, 0, s[88:89]
    v_lshrrev_b32 v41, 16, v70
    v_and_or_b32 v40, v70, s86, v41
    v_add_f32 v192, v192, v194
    v_and_b32 v193, s86, v192
    ds_read_b64_tr_b16 v[104:105], v34 offset:2048
    ds_read_b64_tr_b16 v[106:107], v34 offset:2560
    ds_read_b64_tr_b16 v[108:109], v34 offset:10240
    ds_read_b64_tr_b16 v[110:111], v34 offset:10752
    v_mfma_f32_32x32x16_bf16 v[128:143], v[120:123], a[124:127], v[128:143]
    v_sub_f32 v194, v192, v193
    v_and_b32 v195, s86, v194
    v_sub_f32 v194, v194, v195
    v_lshrrev_b32 v193, 16, v193
    v_or_b32 v44, v193, v195
    v_mfma_f32_32x32x16_bf16 v[160:175], v[120:123], a[252:255], v[160:175]
    v_lshrrev_b32 v45, 16, v194
    v_add_f32 v196, v196, v198
    v_and_b32 v197, s86, v196
    v_sub_f32 v198, v196, v197
    v_and_b32 v199, s86, v198
    v_mfma_f32_32x32x16_bf16 v[144:159], v[124:127], a[124:127], v[144:159]
    buffer_load_dwordx4 v11, s[48:51], s99 offen offset:2048 lds
    v_sub_f32 v198, v198, v199
    v_lshrrev_b32 v197, 16, v197
    v_or_b32 v48, v197, v199
    v_lshrrev_b32 v49, 16, v198
    v_add_f32 v200, v200, v202
    v_mfma_f32_32x32x16_bf16 v[176:191], v[124:127], a[252:255], v[176:191]
    v_and_b32 v201, s86, v200
    v_sub_f32 v202, v200, v201
    v_and_b32 v203, s86, v202
    v_sub_f32 v202, v202, v203
    v_lshrrev_b32 v201, 16, v201
    v_or_b32 v52, v201, v203
    v_lshrrev_b32 v53, 16, v202
    v_add_f32 v204, v204, v206
    v_and_b32 v205, s86, v204
    v_sub_f32 v206, v204, v205
    v_and_b32 v207, s86, v206
    v_sub_f32 v206, v206, v207
    v_lshrrev_b32 v205, 16, v205
    v_or_b32 v54, v205, v207
    v_lshrrev_b32 v55, 16, v206
    v_mfma_f32_32x32x16_bf16 v[128:143], v[44:47], v[36:39], v[128:143]
    v_mfma_f32_32x32x16_bf16 v[160:175], v[44:47], v[40:43], v[160:175]
    v_mfma_f32_32x32x16_bf16 v[144:159], v[48:51], v[36:39], v[144:159]
    v_mfma_f32_32x32x16_bf16 v[176:191], v[48:51], v[40:43], v[176:191]
    ds_read_b64_tr_b16 v[112:113], v34 offset:4096
    ds_read_b64_tr_b16 v[114:115], v34 offset:4608
    ds_read_b64_tr_b16 v[116:117], v34 offset:12288
    ds_read_b64_tr_b16 v[118:119], v34 offset:12800
    s_waitcnt lgkmcnt(10)
    v_mfma_f32_32x32x16_bf16 v[192:207], v[96:99], a[0:3], 0
    s_nop 2
    v_mul_f32 v19, v128, v128
    v_mul_f32 v20, v129, v129
    v_mul_f32 v21, v130, v130
    v_mul_f32 v22, v131, v131
    v_mfma_f32_32x32x16_bf16 v[224:239], v[96:99], a[128:131], 0
    buffer_load_dwordx4 v12, s[48:51], s99 offen offset:3072 lds
    s_add_u32 s100, s100, 128
    s_and_b32 s100, s100, 1023
    v_fma_f32 v19, v19, v30, v28
    v_fma_f32 v20, v20, v30, v28
    v_fma_f32 v21, v21, v30, v28
    v_fma_f32 v22, v22, v30, v28
    s_waitcnt lgkmcnt(8)
    v_mfma_f32_32x32x16_bf16 v[208:223], v[100:103], a[0:3], 0
    v_mul_f32 v19, v19, v128
    v_mul_f32 v20, v20, v129
    v_mul_f32 v21, v21, v130
    v_mul_f32 v22, v22, v131
    v_mfma_f32_32x32x16_bf16 v[240:255], v[100:103], a[128:131], 0
    v_exp_f32 v19, v19
    v_exp_f32 v20, v20
    v_exp_f32 v21, v21
    v_exp_f32 v22, v22
    ds_read_b64_tr_b16 v[120:121], v34 offset:6144
    ds_read_b64_tr_b16 v[122:123], v34 offset:6656
    ds_read_b64_tr_b16 v[124:125], v34 offset:14336
    ds_read_b64_tr_b16 v[126:127], v34 offset:14848
    s_waitcnt lgkmcnt(10)
    v_mfma_f32_32x32x16_bf16 v[192:207], v[104:107], a[4:7], v[192:207]
    v_mul_f32 v144, v144, v128
    v_mul_f32 v145, v145, v129
    v_mul_f32 v146, v146, v130
    v_mul_f32 v147, v147, v131
    v_mfma_f32_32x32x16_bf16 v[224:239], v[104:107], a[132:135], v[224:239]
    v_fma_f32 v19, v19, v32, v32
    v_fma_f32 v20, v20, v32, v32
    v_fma_f32 v21, v21, v32, v32
    v_fma_f32 v22, v22, v32, v32
    s_waitcnt lgkmcnt(8)
    v_mfma_f32_32x32x16_bf16 v[208:223], v[108:111], a[4:7], v[208:223]
    v_rcp_f32 v19, v19
    v_rcp_f32 v20, v20
    v_rcp_f32 v21, v21
    v_rcp_f32 v22, v22
    v_mfma_f32_32x32x16_bf16 v[240:255], v[108:111], a[132:135], v[240:255]
    v_mul_f32 v144, v144, v19
    v_mul_f32 v145, v145, v20
    v_mul_f32 v146, v146, v21
    v_mul_f32 v147, v147, v22
    s_waitcnt lgkmcnt(0)
    v_mfma_f32_32x32x16_bf16 v[192:207], v[112:115], a[8:11], v[192:207]
    s_waitcnt vmcnt(8)
    s_barrier
    ds_read_b64_tr_b16 v[96:97], v35 offset:0
    ds_read_b64_tr_b16 v[98:99], v35 offset:512
    ds_read_b64_tr_b16 v[100:101], v35 offset:8192
    ds_read_b64_tr_b16 v[102:103], v35 offset:8704
    s_mul_i32 s99, s100, 1376
    s_add_u32 s99, s99, s79
    s_add_u32 m0, s80, 32768
    s_nop 0
    buffer_load_dwordx4 v9, s[48:51], s99 offen offset:0 lds
    v_cvt_pk_bf16_f32 v128, v144, v145
    v_cvt_pk_bf16_f32 v129, v146, v147
    v_mul_f32 v19, v132, v132
    v_mul_f32 v20, v133, v133
    v_mfma_f32_32x32x16_bf16 v[224:239], v[112:115], a[136:139], v[224:239]
    v_mul_f32 v21, v134, v134
    v_mul_f32 v22, v135, v135
    v_fma_f32 v19, v19, v30, v28
    v_fma_f32 v20, v20, v30, v28
    v_mfma_f32_32x32x16_bf16 v[208:223], v[116:119], a[8:11], v[208:223]
    v_fma_f32 v21, v21, v30, v28
    v_fma_f32 v22, v22, v30, v28
    v_mul_f32 v19, v19, v132
    v_mul_f32 v20, v20, v133
    v_mfma_f32_32x32x16_bf16 v[240:255], v[116:119], a[136:139], v[240:255]
    buffer_load_dwordx4 v10, s[48:51], s99 offen offset:1024 lds
    v_mul_f32 v21, v21, v134
    v_mul_f32 v22, v22, v135
    v_exp_f32 v19, v19
    v_exp_f32 v20, v20
    ds_read_b64_tr_b16 v[104:105], v35 offset:2048
    ds_read_b64_tr_b16 v[106:107], v35 offset:2560
    ds_read_b64_tr_b16 v[108:109], v35 offset:10240
    ds_read_b64_tr_b16 v[110:111], v35 offset:10752
    v_mfma_f32_32x32x16_bf16 v[192:207], v[120:123], a[12:15], v[192:207]
    v_exp_f32 v21, v21
    v_exp_f32 v22, v22
    v_mul_f32 v148, v148, v132
    v_mul_f32 v149, v149, v133
    v_mfma_f32_32x32x16_bf16 v[224:239], v[120:123], a[140:143], v[224:239]
    v_mul_f32 v150, v150, v134
    v_mul_f32 v151, v151, v135
    v_fma_f32 v19, v19, v32, v32
    v_fma_f32 v20, v20, v32, v32
    v_mfma_f32_32x32x16_bf16 v[208:223], v[124:127], a[12:15], v[208:223]
    buffer_load_dwordx4 v11, s[48:51], s99 offen offset:2048 lds
    v_fma_f32 v21, v21, v32, v32
    v_fma_f32 v22, v22, v32, v32
    v_rcp_f32 v19, v19
    v_rcp_f32 v20, v20
    v_mfma_f32_32x32x16_bf16 v[240:255], v[124:127], a[140:143], v[240:255]
    v_rcp_f32 v21, v21
    v_rcp_f32 v22, v22
    v_mul_f32 v148, v148, v19
    v_mul_f32 v149, v149, v20
    ds_read_b64_tr_b16 v[112:113], v35 offset:4096
    ds_read_b64_tr_b16 v[114:115], v35 offset:4608
    ds_read_b64_tr_b16 v[116:117], v35 offset:12288
    ds_read_b64_tr_b16 v[118:119], v35 offset:12800
    s_waitcnt lgkmcnt(10)
    v_mfma_f32_32x32x16_bf16 v[192:207], v[96:99], a[16:19], v[192:207]
    v_mul_f32 v150, v150, v21
    v_mul_f32 v151, v151, v22
    v_cvt_pk_bf16_f32 v130, v148, v149
    v_cvt_pk_bf16_f32 v131, v150, v151
    v_mfma_f32_32x32x16_bf16 v[224:239], v[96:99], a[144:147], v[224:239]
    buffer_load_dwordx4 v12, s[48:51], s99 offen offset:3072 lds
    s_add_u32 s100, s100, 128
    s_and_b32 s100, s100, 1023
    buffer_store_dwordx4 v[128:131], v27, s[52:55], s81 offen offset:0 sc1
    v_mul_f32 v19, v136, v136
    v_mul_f32 v20, v137, v137
    v_mul_f32 v21, v138, v138
    s_waitcnt lgkmcnt(8)
    v_mfma_f32_32x32x16_bf16 v[208:223], v[100:103], a[16:19], v[208:223]
    v_mul_f32 v22, v139, v139
    v_fma_f32 v19, v19, v30, v28
    v_fma_f32 v20, v20, v30, v28
    v_fma_f32 v21, v21, v30, v28
    v_mfma_f32_32x32x16_bf16 v[240:255], v[100:103], a[144:147], v[240:255]
    v_fma_f32 v22, v22, v30, v28
    v_mul_f32 v19, v19, v136
    v_mul_f32 v20, v20, v137
    v_mul_f32 v21, v21, v138
    ds_read_b64_tr_b16 v[120:121], v35 offset:6144
    ds_read_b64_tr_b16 v[122:123], v35 offset:6656
    ds_read_b64_tr_b16 v[124:125], v35 offset:14336
    ds_read_b64_tr_b16 v[126:127], v35 offset:14848
    s_waitcnt lgkmcnt(10)
    v_mfma_f32_32x32x16_bf16 v[192:207], v[104:107], a[20:23], v[192:207]
    v_mul_f32 v22, v22, v139
    v_exp_f32 v19, v19
    v_exp_f32 v20, v20
    v_exp_f32 v21, v21
    v_mfma_f32_32x32x16_bf16 v[224:239], v[104:107], a[148:151], v[224:239]
    v_exp_f32 v22, v22
    v_mul_f32 v152, v152, v136
    v_mul_f32 v153, v153, v137
    v_mul_f32 v154, v154, v138
    s_waitcnt lgkmcnt(8)
    v_mfma_f32_32x32x16_bf16 v[208:223], v[108:111], a[20:23], v[208:223]
    v_mul_f32 v155, v155, v139
    v_fma_f32 v19, v19, v32, v32
    v_fma_f32 v20, v20, v32, v32
    v_fma_f32 v21, v21, v32, v32
    v_mfma_f32_32x32x16_bf16 v[240:255], v[108:111], a[148:151], v[240:255]
    v_fma_f32 v22, v22, v32, v32
    v_rcp_f32 v19, v19
    v_rcp_f32 v20, v20
    v_rcp_f32 v21, v21
    s_waitcnt lgkmcnt(0)
    v_mfma_f32_32x32x16_bf16 v[192:207], v[112:115], a[24:27], v[192:207]
    s_waitcnt vmcnt(9)
    s_barrier
    ds_read_b64_tr_b16 v[96:97], v34 offset:16384
    ds_read_b64_tr_b16 v[98:99], v34 offset:16896
    ds_read_b64_tr_b16 v[100:101], v34 offset:24576
    ds_read_b64_tr_b16 v[102:103], v34 offset:25088
    s_mul_i32 s99, s100, 1376
    s_add_u32 s99, s99, s79
    s_add_u32 m0, s80, 98304
    s_nop 0
    buffer_load_dwordx4 v9, s[48:51], s99 offen offset:0 lds
    v_rcp_f32 v22, v22
    v_mul_f32 v152, v152, v19
    v_mul_f32 v153, v153, v20
    v_mul_f32 v154, v154, v21
    v_mfma_f32_32x32x16_bf16 v[224:239], v[112:115], a[152:155], v[224:239]
    v_mul_f32 v155, v155, v22
    v_cvt_pk_bf16_f32 v136, v152, v153
    v_cvt_pk_bf16_f32 v137, v154, v155
    v_mul_f32 v19, v140, v140
    v_mfma_f32_32x32x16_bf16 v[208:223], v[116:119], a[24:27], v[208:223]
    v_mul_f32 v20, v141, v141
    v_mul_f32 v21, v142, v142
    v_mul_f32 v22, v143, v143
    v_fma_f32 v19, v19, v30, v28
    v_mfma_f32_32x32x16_bf16 v[240:255], v[116:119], a[152:155], v[240:255]
    buffer_load_dwordx4 v10, s[48:51], s99 offen offset:1024 lds
    v_fma_f32 v20, v20, v30, v28
    v_fma_f32 v21, v21, v30, v28
    v_fma_f32 v22, v22, v30, v28
    v_mul_f32 v19, v19, v140
    ds_read_b64_tr_b16 v[104:105], v34 offset:18432
    ds_read_b64_tr_b16 v[106:107], v34 offset:18944
    ds_read_b64_tr_b16 v[108:109], v34 offset:26624
    ds_read_b64_tr_b16 v[110:111], v34 offset:27136
    v_mfma_f32_32x32x16_bf16 v[192:207], v[120:123], a[28:31], v[192:207]
    v_mul_f32 v20, v20, v141
    v_mul_f32 v21, v21, v142
    v_mul_f32 v22, v22, v143
    v_exp_f32 v19, v19
    v_mfma_f32_32x32x16_bf16 v[224:239], v[120:123], a[156:159], v[224:239]
    v_exp_f32 v20, v20
    v_exp_f32 v21, v21
    v_exp_f32 v22, v22
    v_mul_f32 v156, v156, v140
    v_mfma_f32_32x32x16_bf16 v[208:223], v[124:127], a[28:31], v[208:223]
    buffer_load_dwordx4 v11, s[48:51], s99 offen offset:2048 lds
    v_mul_f32 v157, v157, v141
    v_mul_f32 v158, v158, v142
    v_mul_f32 v159, v159, v143
    v_fma_f32 v19, v19, v32, v32
    v_mfma_f32_32x32x16_bf16 v[240:255], v[124:127], a[156:159], v[240:255]
    v_fma_f32 v20, v20, v32, v32
    v_fma_f32 v21, v21, v32, v32
    v_fma_f32 v22, v22, v32, v32
    v_rcp_f32 v19, v19
    ds_read_b64_tr_b16 v[112:113], v34 offset:20480
    ds_read_b64_tr_b16 v[114:115], v34 offset:20992
    ds_read_b64_tr_b16 v[116:117], v34 offset:28672
    ds_read_b64_tr_b16 v[118:119], v34 offset:29184
    s_waitcnt lgkmcnt(10)
    v_mfma_f32_32x32x16_bf16 v[192:207], v[96:99], a[32:35], v[192:207]
    v_rcp_f32 v20, v20
    v_rcp_f32 v21, v21
    v_rcp_f32 v22, v22
    v_mul_f32 v156, v156, v19
    v_mfma_f32_32x32x16_bf16 v[224:239], v[96:99], a[160:163], v[224:239]
    buffer_load_dwordx4 v12, s[48:51], s99 offen offset:3072 lds
    s_add_u32 s100, s100, 128
    s_and_b32 s100, s100, 1023
    v_mul_f32 v157, v157, v20
    v_mul_f32 v158, v158, v21
    v_mul_f32 v159, v159, v22
    v_cvt_pk_bf16_f32 v138, v156, v157
    s_waitcnt lgkmcnt(8)
    v_mfma_f32_32x32x16_bf16 v[208:223], v[100:103], a[32:35], v[208:223]
    v_cvt_pk_bf16_f32 v139, v158, v159
    buffer_store_dwordx4 v[136:139], v27, s[52:55], s81 offen offset:1024 sc1
    v_mul_f32 v19, v160, v160
    v_mul_f32 v20, v161, v161
    v_mfma_f32_32x32x16_bf16 v[240:255], v[100:103], a[160:163], v[240:255]
    v_mul_f32 v21, v162, v162
    v_mul_f32 v22, v163, v163
    v_fma_f32 v19, v19, v31, v29
    v_fma_f32 v20, v20, v31, v29
    ds_read_b64_tr_b16 v[120:121], v34 offset:22528
    ds_read_b64_tr_b16 v[122:123], v34 offset:23040
    ds_read_b64_tr_b16 v[124:125], v34 offset:30720
    ds_read_b64_tr_b16 v[126:127], v34 offset:31232
    s_waitcnt lgkmcnt(10)
    v_mfma_f32_32x32x16_bf16 v[192:207], v[104:107], a[36:39], v[192:207]
    v_fma_f32 v21, v21, v31, v29
    v_fma_f32 v22, v22, v31, v29
    v_mul_f32 v19, v19, v160
    v_mul_f32 v20, v20, v161
    v_mfma_f32_32x32x16_bf16 v[224:239], v[104:107], a[164:167], v[224:239]
    v_mul_f32 v21, v21, v162
    v_mul_f32 v22, v22, v163
    v_exp_f32 v19, v19
    v_exp_f32 v20, v20
    s_waitcnt lgkmcnt(8)
    v_mfma_f32_32x32x16_bf16 v[208:223], v[108:111], a[36:39], v[208:223]
    v_exp_f32 v21, v21
    v_exp_f32 v22, v22
    v_mul_f32 v176, v176, v160
    v_mul_f32 v177, v177, v161
    v_mfma_f32_32x32x16_bf16 v[240:255], v[108:111], a[164:167], v[240:255]
    v_mul_f32 v178, v178, v162
    v_mul_f32 v179, v179, v163
    v_fma_f32 v19, v19, v33, v33
    v_fma_f32 v20, v20, v33, v33
    s_waitcnt lgkmcnt(0)
    v_mfma_f32_32x32x16_bf16 v[192:207], v[112:115], a[40:43], v[192:207]
    s_waitcnt vmcnt(10)
    s_barrier
    ds_read_b64_tr_b16 v[96:97], v35 offset:16384
    ds_read_b64_tr_b16 v[98:99], v35 offset:16896
    ds_read_b64_tr_b16 v[100:101], v35 offset:24576
    ds_read_b64_tr_b16 v[102:103], v35 offset:25088
    s_mul_i32 s99, s100, 1376
    s_add_u32 s99, s99, s79
    s_add_u32 m0, s80, 49152
    s_nop 0
    buffer_load_dwordx4 v9, s[48:51], s99 offen offset:0 lds
    v_fma_f32 v21, v21, v33, v33
    v_fma_f32 v22, v22, v33, v33
    v_rcp_f32 v19, v19
    v_rcp_f32 v20, v20
    v_mfma_f32_32x32x16_bf16 v[224:239], v[112:115], a[168:171], v[224:239]
    v_rcp_f32 v21, v21
    v_rcp_f32 v22, v22
    v_mul_f32 v176, v176, v19
    v_mul_f32 v177, v177, v20
    v_mfma_f32_32x32x16_bf16 v[208:223], v[116:119], a[40:43], v[208:223]
    v_mul_f32 v178, v178, v21
    v_mul_f32 v179, v179, v22
    v_cvt_pk_bf16_f32 v160, v176, v177
    v_cvt_pk_bf16_f32 v161, v178, v179
    v_mfma_f32_32x32x16_bf16 v[240:255], v[116:119], a[168:171], v[240:255]
    buffer_load_dwordx4 v10, s[48:51], s99 offen offset:1024 lds
    v_mul_f32 v19, v164, v164
    v_mul_f32 v20, v165, v165
    v_mul_f32 v21, v166, v166
    v_mul_f32 v22, v167, v167
    ds_read_b64_tr_b16 v[104:105], v35 offset:18432
    ds_read_b64_tr_b16 v[106:107], v35 offset:18944
    ds_read_b64_tr_b16 v[108:109], v35 offset:26624
    ds_read_b64_tr_b16 v[110:111], v35 offset:27136
    v_mfma_f32_32x32x16_bf16 v[192:207], v[120:123], a[44:47], v[192:207]
    v_fma_f32 v19, v19, v31, v29
    v_fma_f32 v20, v20, v31, v29
    v_fma_f32 v21, v21, v31, v29
    v_fma_f32 v22, v22, v31, v29
    v_mfma_f32_32x32x16_bf16 v[224:239], v[120:123], a[172:175], v[224:239]
    v_mul_f32 v19, v19, v164
    v_mul_f32 v20, v20, v165
    v_mul_f32 v21, v21, v166
    v_mul_f32 v22, v22, v167
    v_mfma_f32_32x32x16_bf16 v[208:223], v[124:127], a[44:47], v[208:223]
    buffer_load_dwordx4 v11, s[48:51], s99 offen offset:2048 lds
    v_exp_f32 v19, v19
    v_exp_f32 v20, v20
    v_exp_f32 v21, v21
    v_exp_f32 v22, v22
    v_mfma_f32_32x32x16_bf16 v[240:255], v[124:127], a[172:175], v[240:255]
    v_mul_f32 v180, v180, v164
    v_mul_f32 v181, v181, v165
    v_mul_f32 v182, v182, v166
    v_mul_f32 v183, v183, v167
    ds_read_b64_tr_b16 v[112:113], v35 offset:20480
    ds_read_b64_tr_b16 v[114:115], v35 offset:20992
    ds_read_b64_tr_b16 v[116:117], v35 offset:28672
    ds_read_b64_tr_b16 v[118:119], v35 offset:29184
    s_waitcnt lgkmcnt(10)
    v_mfma_f32_32x32x16_bf16 v[192:207], v[96:99], a[48:51], v[192:207]
    v_fma_f32 v19, v19, v33, v33
    v_fma_f32 v20, v20, v33, v33
    v_fma_f32 v21, v21, v33, v33
    v_fma_f32 v22, v22, v33, v33
    v_mfma_f32_32x32x16_bf16 v[224:239], v[96:99], a[176:179], v[224:239]
    buffer_load_dwordx4 v12, s[48:51], s99 offen offset:3072 lds
    s_add_u32 s100, s100, 128
    s_and_b32 s100, s100, 1023
    v_rcp_f32 v19, v19
    v_rcp_f32 v20, v20
    v_rcp_f32 v21, v21
    v_rcp_f32 v22, v22
    s_waitcnt lgkmcnt(8)
    v_mfma_f32_32x32x16_bf16 v[208:223], v[100:103], a[48:51], v[208:223]
    v_mul_f32 v180, v180, v19
    v_mul_f32 v181, v181, v20
    v_mul_f32 v182, v182, v21
    v_mul_f32 v183, v183, v22
    v_mfma_f32_32x32x16_bf16 v[240:255], v[100:103], a[176:179], v[240:255]
    v_cvt_pk_bf16_f32 v162, v180, v181
    v_cvt_pk_bf16_f32 v163, v182, v183
    buffer_store_dwordx4 v[160:163], v27, s[56:59], s81 offen offset:0 sc1
    v_mul_f32 v19, v168, v168
    ds_read_b64_tr_b16 v[120:121], v35 offset:22528
    ds_read_b64_tr_b16 v[122:123], v35 offset:23040
    ds_read_b64_tr_b16 v[124:125], v35 offset:30720
    ds_read_b64_tr_b16 v[126:127], v35 offset:31232
    s_waitcnt lgkmcnt(10)
    v_mfma_f32_32x32x16_bf16 v[192:207], v[104:107], a[52:55], v[192:207]
    v_mul_f32 v20, v169, v169
    v_mul_f32 v21, v170, v170
    v_mul_f32 v22, v171, v171
    v_fma_f32 v19, v19, v31, v29
    v_mfma_f32_32x32x16_bf16 v[224:239], v[104:107], a[180:183], v[224:239]
    v_fma_f32 v20, v20, v31, v29
    v_fma_f32 v21, v21, v31, v29
    v_fma_f32 v22, v22, v31, v29
    v_mul_f32 v19, v19, v168
    s_waitcnt lgkmcnt(8)
    v_mfma_f32_32x32x16_bf16 v[208:223], v[108:111], a[52:55], v[208:223]
    v_mul_f32 v20, v20, v169
    v_mul_f32 v21, v21, v170
    v_mul_f32 v22, v22, v171
    v_exp_f32 v19, v19
    v_mfma_f32_32x32x16_bf16 v[240:255], v[108:111], a[180:183], v[240:255]
    v_exp_f32 v20, v20
    v_exp_f32 v21, v21
    v_exp_f32 v22, v22
    v_mul_f32 v184, v184, v168
    s_waitcnt lgkmcnt(0)
    v_mfma_f32_32x32x16_bf16 v[192:207], v[112:115], a[56:59], v[192:207]
    s_waitcnt vmcnt(11)
    s_barrier
    ds_read_b64_tr_b16 v[96:97], v34 offset:32768
    ds_read_b64_tr_b16 v[98:99], v34 offset:33280
    ds_read_b64_tr_b16 v[100:101], v34 offset:40960
    ds_read_b64_tr_b16 v[102:103], v34 offset:41472
    s_mul_i32 s99, s100, 1376
    s_add_u32 s99, s99, s79
    s_add_u32 m0, s80, 114688
    s_nop 0
    buffer_load_dwordx4 v9, s[48:51], s99 offen offset:0 lds
    v_mul_f32 v185, v185, v169
    v_mul_f32 v186, v186, v170
    v_mul_f32 v187, v187, v171
    v_fma_f32 v19, v19, v33, v33
    v_mfma_f32_32x32x16_bf16 v[224:239], v[112:115], a[184:187], v[224:239]
    v_fma_f32 v20, v20, v33, v33
    v_fma_f32 v21, v21, v33, v33
    v_fma_f32 v22, v22, v33, v33
    v_rcp_f32 v19, v19
    v_mfma_f32_32x32x16_bf16 v[208:223], v[116:119], a[56:59], v[208:223]
    v_rcp_f32 v20, v20
    v_rcp_f32 v21, v21
    v_rcp_f32 v22, v22
    v_mul_f32 v184, v184, v19
    v_mfma_f32_32x32x16_bf16 v[240:255], v[116:119], a[184:187], v[240:255]
    buffer_load_dwordx4 v10, s[48:51], s99 offen offset:1024 lds
    v_mul_f32 v185, v185, v20
    v_mul_f32 v186, v186, v21
    v_mul_f32 v187, v187, v22
    v_cvt_pk_bf16_f32 v168, v184, v185
    ds_read_b64_tr_b16 v[104:105], v34 offset:34816
    ds_read_b64_tr_b16 v[106:107], v34 offset:35328
    ds_read_b64_tr_b16 v[108:109], v34 offset:43008
    ds_read_b64_tr_b16 v[110:111], v34 offset:43520
    v_mfma_f32_32x32x16_bf16 v[192:207], v[120:123], a[60:63], v[192:207]
    v_cvt_pk_bf16_f32 v169, v186, v187
    v_mul_f32 v19, v172, v172
    v_mul_f32 v20, v173, v173
    v_mul_f32 v21, v174, v174
    v_mfma_f32_32x32x16_bf16 v[224:239], v[120:123], a[188:191], v[224:239]
    v_mul_f32 v22, v175, v175
    v_fma_f32 v19, v19, v31, v29
    v_fma_f32 v20, v20, v31, v29
    v_fma_f32 v21, v21, v31, v29
    v_mfma_f32_32x32x16_bf16 v[208:223], v[124:127], a[60:63], v[208:223]
    buffer_load_dwordx4 v11, s[48:51], s99 offen offset:2048 lds
    v_fma_f32 v22, v22, v31, v29
    v_mul_f32 v19, v19, v172
    v_mul_f32 v20, v20, v173
    v_mul_f32 v21, v21, v174
    v_mfma_f32_32x32x16_bf16 v[240:255], v[124:127], a[188:191], v[240:255]
    v_mul_f32 v22, v22, v175
    v_exp_f32 v19, v19
    v_exp_f32 v20, v20
    v_exp_f32 v21, v21
    ds_read_b64_tr_b16 v[112:113], v34 offset:36864
    ds_read_b64_tr_b16 v[114:115], v34 offset:37376
    ds_read_b64_tr_b16 v[116:117], v34 offset:45056
    ds_read_b64_tr_b16 v[118:119], v34 offset:45568
    s_waitcnt lgkmcnt(10)
    v_mfma_f32_32x32x16_bf16 v[192:207], v[96:99], a[64:67], v[192:207]
    v_exp_f32 v22, v22
    v_mul_f32 v188, v188, v172
    v_mul_f32 v189, v189, v173
    v_mul_f32 v190, v190, v174
    v_mfma_f32_32x32x16_bf16 v[224:239], v[96:99], a[192:195], v[224:239]
    buffer_load_dwordx4 v12, s[48:51], s99 offen offset:3072 lds
    s_add_u32 s100, s100, 128
    s_and_b32 s100, s100, 1023
    v_mul_f32 v191, v191, v175
    v_fma_f32 v19, v19, v33, v33
    v_fma_f32 v20, v20, v33, v33
    v_fma_f32 v21, v21, v33, v33
    s_waitcnt lgkmcnt(8)
    v_mfma_f32_32x32x16_bf16 v[208:223], v[100:103], a[64:67], v[208:223]
    v_fma_f32 v22, v22, v33, v33
    v_rcp_f32 v19, v19
    v_rcp_f32 v20, v20
    v_rcp_f32 v21, v21
    v_mfma_f32_32x32x16_bf16 v[240:255], v[100:103], a[192:195], v[240:255]
    v_rcp_f32 v22, v22
    v_mul_f32 v188, v188, v19
    v_mul_f32 v189, v189, v20
    v_mul_f32 v190, v190, v21
    ds_read_b64_tr_b16 v[120:121], v34 offset:38912
    ds_read_b64_tr_b16 v[122:123], v34 offset:39424
    ds_read_b64_tr_b16 v[124:125], v34 offset:47104
    ds_read_b64_tr_b16 v[126:127], v34 offset:47616
    s_waitcnt lgkmcnt(10)
    v_mfma_f32_32x32x16_bf16 v[192:207], v[104:107], a[68:71], v[192:207]
    v_mul_f32 v191, v191, v22
    v_cvt_pk_bf16_f32 v170, v188, v189
    v_cvt_pk_bf16_f32 v171, v190, v191
    buffer_store_dwordx4 v[168:171], v27, s[56:59], s81 offen offset:1024 sc1
    v_mfma_f32_32x32x16_bf16 v[224:239], v[104:107], a[196:199], v[224:239]
    s_and_b32 s83, s3, 7
    s_lshl_b32 s83, s83, 2
    s_and_b32 s84, s4, 3
    s_add_u32 s83, s83, s84
    s_waitcnt lgkmcnt(8)
    v_mfma_f32_32x32x16_bf16 v[208:223], v[108:111], a[68:71], v[208:223]
    s_mov_b32 s68, s32
    s_mov_b32 s69, s33
    s_mov_b32 s70, 1409024
    s_mov_b32 s71, 0x20000
    v_mfma_f32_32x32x16_bf16 v[240:255], v[108:111], a[196:199], v[240:255]
    v_lshrrev_b32 v56, 2, v1
    v_lshlrev_b32 v56, 10, v56
    v_and_b32 v57, 3, v1
    v_lshl_add_u32 v56, v57, 7, v56
    s_waitcnt lgkmcnt(0)
    v_mfma_f32_32x32x16_bf16 v[192:207], v[112:115], a[72:75], v[192:207]
    s_waitcnt vmcnt(11)
    s_barrier
    ds_read_b64_tr_b16 v[96:97], v35 offset:32768
    ds_read_b64_tr_b16 v[98:99], v35 offset:33280
    ds_read_b64_tr_b16 v[100:101], v35 offset:40960
    ds_read_b64_tr_b16 v[102:103], v35 offset:41472
    s_mul_i32 s84, s83, 44032
    s_bfe_u32 s92, s4, 0x10002
    s_lshl_b32 s92, s92, 9
    s_add_u32 s84, s84, s92
    v_mfma_f32_32x32x16_bf16 v[224:239], v[112:115], a[200:203], v[224:239]
    s_lshl_b32 s92, s6, 15
    s_add_u32 s84, s84, s92
    buffer_load_dword v58, v56, s[68:71], s84 offen
    s_add_u32 s84, s84, 16384
    v_mfma_f32_32x32x16_bf16 v[208:223], v[116:119], a[72:75], v[208:223]
    buffer_load_dword v59, v56, s[68:71], s84 offen
    s_cmp_eq_u32 s6, 0
    s_cselect_b32 s68, s18, s20
    s_cselect_b32 s69, s19, s21
    v_mfma_f32_32x32x16_bf16 v[240:255], v[116:119], a[200:203], v[240:255]
    s_mov_b32 s70, 524288
    v_lshlrev_b32 v56, 7, v1
    s_bfe_u32 s92, s4, 0x10002
    s_lshl_b32 s92, s92, 18
    ds_read_b64_tr_b16 v[104:105], v35 offset:34816
    ds_read_b64_tr_b16 v[106:107], v35 offset:35328
    ds_read_b64_tr_b16 v[108:109], v35 offset:43008
    ds_read_b64_tr_b16 v[110:111], v35 offset:43520
    v_mfma_f32_32x32x16_bf16 v[192:207], v[120:123], a[76:79], v[192:207]
    s_lshl_b32 s84, s83, 13
    s_add_u32 s84, s84, s92
    buffer_load_dword v60, v56, s[68:71], s84 offen
    v_mfma_f32_32x32x16_bf16 v[224:239], v[120:123], a[204:207], v[224:239]
    v_mfma_f32_32x32x16_bf16 v[208:223], v[124:127], a[76:79], v[208:223]
    v_mfma_f32_32x32x16_bf16 v[240:255], v[124:127], a[204:207], v[240:255]
    ds_read_b64_tr_b16 v[112:113], v35 offset:36864
    ds_read_b64_tr_b16 v[114:115], v35 offset:37376
    ds_read_b64_tr_b16 v[116:117], v35 offset:45056
    ds_read_b64_tr_b16 v[118:119], v35 offset:45568
    s_waitcnt lgkmcnt(10)
    v_mfma_f32_32x32x16_bf16 v[192:207], v[96:99], a[80:83], v[192:207]
    v_mfma_f32_32x32x16_bf16 v[224:239], v[96:99], a[208:211], v[224:239]
    s_waitcnt lgkmcnt(8)
    v_mfma_f32_32x32x16_bf16 v[208:223], v[100:103], a[80:83], v[208:223]
    v_mfma_f32_32x32x16_bf16 v[240:255], v[100:103], a[208:211], v[240:255]
    ds_read_b64_tr_b16 v[120:121], v35 offset:38912
    ds_read_b64_tr_b16 v[122:123], v35 offset:39424
    ds_read_b64_tr_b16 v[124:125], v35 offset:47104
    ds_read_b64_tr_b16 v[126:127], v35 offset:47616
    s_waitcnt lgkmcnt(10)
    v_mfma_f32_32x32x16_bf16 v[192:207], v[104:107], a[84:87], v[192:207]
    v_mfma_f32_32x32x16_bf16 v[224:239], v[104:107], a[212:215], v[224:239]
    s_waitcnt lgkmcnt(8)
    v_mfma_f32_32x32x16_bf16 v[208:223], v[108:111], a[84:87], v[208:223]
    v_mfma_f32_32x32x16_bf16 v[240:255], v[108:111], a[212:215], v[240:255]
    s_waitcnt lgkmcnt(0)
    v_mfma_f32_32x32x16_bf16 v[192:207], v[112:115], a[88:91], v[192:207]
    s_waitcnt vmcnt(9)
    s_barrier
    ds_read_b64_tr_b16 v[96:97], v34 offset:49152
    ds_read_b64_tr_b16 v[98:99], v34 offset:49664
    ds_read_b64_tr_b16 v[100:101], v34 offset:57344
    ds_read_b64_tr_b16 v[102:103], v34 offset:57856
    v_mfma_f32_32x32x16_bf16 v[224:239], v[112:115], a[216:219], v[224:239]
    v_mfma_f32_32x32x16_bf16 v[208:223], v[116:119], a[88:91], v[208:223]
    v_mfma_f32_32x32x16_bf16 v[240:255], v[116:119], a[216:219], v[240:255]
    ds_read_b64_tr_b16 v[104:105], v34 offset:51200
    ds_read_b64_tr_b16 v[106:107], v34 offset:51712
    ds_read_b64_tr_b16 v[108:109], v34 offset:59392
    ds_read_b64_tr_b16 v[110:111], v34 offset:59904
    v_mfma_f32_32x32x16_bf16 v[192:207], v[120:123], a[92:95], v[192:207]
    v_mfma_f32_32x32x16_bf16 v[224:239], v[120:123], a[220:223], v[224:239]
    v_mfma_f32_32x32x16_bf16 v[208:223], v[124:127], a[92:95], v[208:223]
    v_mfma_f32_32x32x16_bf16 v[240:255], v[124:127], a[220:223], v[240:255]
    ds_read_b64_tr_b16 v[112:113], v34 offset:53248
    ds_read_b64_tr_b16 v[114:115], v34 offset:53760
    ds_read_b64_tr_b16 v[116:117], v34 offset:61440
    ds_read_b64_tr_b16 v[118:119], v34 offset:61952
    s_waitcnt lgkmcnt(10)
    v_mfma_f32_32x32x16_bf16 v[192:207], v[96:99], a[96:99], v[192:207]
    v_mfma_f32_32x32x16_bf16 v[224:239], v[96:99], a[224:227], v[224:239]
    s_waitcnt lgkmcnt(8)
    v_mfma_f32_32x32x16_bf16 v[208:223], v[100:103], a[96:99], v[208:223]
    v_mfma_f32_32x32x16_bf16 v[240:255], v[100:103], a[224:227], v[240:255]
    ds_read_b64_tr_b16 v[120:121], v34 offset:55296
    ds_read_b64_tr_b16 v[122:123], v34 offset:55808
    ds_read_b64_tr_b16 v[124:125], v34 offset:63488
    ds_read_b64_tr_b16 v[126:127], v34 offset:64000
    s_waitcnt lgkmcnt(10)
    v_mfma_f32_32x32x16_bf16 v[192:207], v[104:107], a[100:103], v[192:207]
    v_mfma_f32_32x32x16_bf16 v[224:239], v[104:107], a[228:231], v[224:239]
    s_waitcnt lgkmcnt(8)
    v_mfma_f32_32x32x16_bf16 v[208:223], v[108:111], a[100:103], v[208:223]
    v_mfma_f32_32x32x16_bf16 v[240:255], v[108:111], a[228:231], v[240:255]
    s_waitcnt lgkmcnt(0)
    v_mfma_f32_32x32x16_bf16 v[192:207], v[112:115], a[104:107], v[192:207]
    s_waitcnt vmcnt(4)
    s_barrier
    ds_read_b64_tr_b16 v[96:97], v35 offset:49152
    ds_read_b64_tr_b16 v[98:99], v35 offset:49664
    ds_read_b64_tr_b16 v[100:101], v35 offset:57344
    ds_read_b64_tr_b16 v[102:103], v35 offset:57856
    v_mfma_f32_32x32x16_bf16 v[224:239], v[112:115], a[232:235], v[224:239]
    v_mfma_f32_32x32x16_bf16 v[208:223], v[116:119], a[104:107], v[208:223]
    v_mfma_f32_32x32x16_bf16 v[240:255], v[116:119], a[232:235], v[240:255]
    ds_read_b64_tr_b16 v[104:105], v35 offset:51200
    ds_read_b64_tr_b16 v[106:107], v35 offset:51712
    ds_read_b64_tr_b16 v[108:109], v35 offset:59392
    ds_read_b64_tr_b16 v[110:111], v35 offset:59904
    v_mfma_f32_32x32x16_bf16 v[192:207], v[120:123], a[108:111], v[192:207]
    v_mfma_f32_32x32x16_bf16 v[224:239], v[120:123], a[236:239], v[224:239]
    v_mfma_f32_32x32x16_bf16 v[208:223], v[124:127], a[108:111], v[208:223]
    v_mfma_f32_32x32x16_bf16 v[240:255], v[124:127], a[236:239], v[240:255]
    ds_read_b64_tr_b16 v[112:113], v35 offset:53248
    ds_read_b64_tr_b16 v[114:115], v35 offset:53760
    ds_read_b64_tr_b16 v[116:117], v35 offset:61440
    ds_read_b64_tr_b16 v[118:119], v35 offset:61952
    s_waitcnt lgkmcnt(10)
    v_mfma_f32_32x32x16_bf16 v[192:207], v[96:99], a[112:115], v[192:207]
    v_mfma_f32_32x32x16_bf16 v[224:239], v[96:99], a[240:243], v[224:239]
    s_waitcnt lgkmcnt(8)
    v_mfma_f32_32x32x16_bf16 v[208:223], v[100:103], a[112:115], v[208:223]
    v_mfma_f32_32x32x16_bf16 v[240:255], v[100:103], a[240:243], v[240:255]
    ds_read_b64_tr_b16 v[120:121], v35 offset:55296
    ds_read_b64_tr_b16 v[122:123], v35 offset:55808
    ds_read_b64_tr_b16 v[124:125], v35 offset:63488
    ds_read_b64_tr_b16 v[126:127], v35 offset:64000
    s_waitcnt lgkmcnt(10)
    v_mfma_f32_32x32x16_bf16 v[192:207], v[104:107], a[116:119], v[192:207]
    v_mfma_f32_32x32x16_bf16 v[224:239], v[104:107], a[244:247], v[224:239]
    s_waitcnt lgkmcnt(8)
    v_mfma_f32_32x32x16_bf16 v[208:223], v[108:111], a[116:119], v[208:223]
    v_mfma_f32_32x32x16_bf16 v[240:255], v[108:111], a[244:247], v[240:255]
    s_waitcnt lgkmcnt(6)
    v_mfma_f32_32x32x16_bf16 v[192:207], v[112:115], a[120:123], v[192:207]
    v_mfma_f32_32x32x16_bf16 v[224:239], v[112:115], a[248:251], v[224:239]
    s_waitcnt lgkmcnt(4)
    v_mfma_f32_32x32x16_bf16 v[208:223], v[116:119], a[120:123], v[208:223]
    v_mfma_f32_32x32x16_bf16 v[240:255], v[116:119], a[248:251], v[240:255]
    s_waitcnt lgkmcnt(2)
    v_mfma_f32_32x32x16_bf16 v[192:207], v[120:123], a[124:127], v[192:207]
    v_mfma_f32_32x32x16_bf16 v[224:239], v[120:123], a[252:255], v[224:239]
    s_waitcnt lgkmcnt(0)
    v_mfma_f32_32x32x16_bf16 v[208:223], v[124:127], a[124:127], v[208:223]
    v_mfma_f32_32x32x16_bf16 v[240:255], v[124:127], a[252:255], v[240:255]
    v_mov_b32 v44, v52
    v_mov_b32 v45, v53
    v_mov_b32 v48, v54
    v_mov_b32 v49, v55
    v_mfma_f32_32x32x16_bf16 v[192:207], v[44:47], v[36:39], v[192:207]
    v_mfma_f32_32x32x16_bf16 v[224:239], v[44:47], v[40:43], v[224:239]
    v_mfma_f32_32x32x16_bf16 v[208:223], v[48:51], v[36:39], v[208:223]
    v_mfma_f32_32x32x16_bf16 v[240:255], v[48:51], v[40:43], v[240:255]
    s_barrier
    s_lshl_b32 s78, s5, 15
    v_lshrrev_b32 v26, 3, v1
    v_bfe_u32 v4, v1, 4, 1
    v_lshlrev_b32 v4, 2, v4
    v_and_b32 v6, 7, v1
    v_xor_b32 v4, v4, v6
    v_lshlrev_b32 v4, 4, v4
    v_lshl_add_u32 v5, v26, 10, v4
    v_add_u32 v6, 7168, v5
    s_mov_b32 s44, s32
    s_mov_b32 s45, s33
    s_mov_b32 s46, 1409024
    s_mov_b32 s47, 0x20000
    s_and_b32 s76, s4, 7
    s_lshl_b32 s77, s76, 7
    s_lshl_b32 s99, s5, 14
    s_add_u32 s77, s77, s99
    v_mov_b32 v36, v28
    s_add_u32 m0, s78, 0
    s_nop 0
    buffer_load_dwordx4 v5, s[44:47], s77 offen lds
    v_mov_b32 v37, v30
    v_mov_b32 v38, v32
    v_mov_b32 v40, v29
    buffer_load_dwordx4 v6, s[44:47], s77 offen offset:1024 lds
    s_add_u32 s77, s77, 65536
    v_mov_b32 v41, v31
    v_mov_b32 v42, v33
    s_add_u32 m0, s78, 2048
    s_nop 0
    buffer_load_dwordx4 v5, s[44:47], s77 offen lds
    v_pk_mul_f32 v[44:45], v[192:193], v[192:193]
    v_pk_mul_f32 v[48:49], v[224:225], v[224:225]
    buffer_load_dwordx4 v6, s[44:47], s77 offen offset:1024 lds
    s_add_u32 s77, s77, 65536
    v_pk_mul_f32 v[46:47], v[194:195], v[194:195]
    v_pk_mul_f32 v[50:51], v[226:227], v[226:227]
    s_add_u32 m0, s78, 4096
    s_nop 0
    buffer_load_dwordx4 v5, s[44:47], s77 offen lds
    v_pk_fma_f32 v[44:45], v[44:45], v[36:37], v[36:37] op_sel:[0,1,0] op_sel_hi:[1,1,0]
    v_pk_fma_f32 v[48:49], v[48:49], v[40:41], v[40:41] op_sel:[0,1,0] op_sel_hi:[1,1,0]
    buffer_load_dwordx4 v6, s[44:47], s77 offen offset:1024 lds
    s_add_u32 s77, s77, 65536
    v_pk_fma_f32 v[46:47], v[46:47], v[36:37], v[36:37] op_sel:[0,1,0] op_sel_hi:[1,1,0]
    v_pk_fma_f32 v[50:51], v[50:51], v[40:41], v[40:41] op_sel:[0,1,0] op_sel_hi:[1,1,0]
    s_add_u32 m0, s78, 6144
    s_nop 0
    buffer_load_dwordx4 v5, s[44:47], s77 offen lds
    v_pk_mul_f32 v[44:45], v[44:45], v[192:193]
    v_pk_mul_f32 v[48:49], v[48:49], v[224:225]
    v_pk_mul_f32 v[46:47], v[46:47], v[194:195]
    buffer_load_dwordx4 v6, s[44:47], s77 offen offset:1024 lds
    s_add_u32 s77, s77, 65536
    v_pk_mul_f32 v[50:51], v[50:51], v[226:227]
    v_exp_f32 v44, v44
    s_add_u32 m0, s78, 8192
    s_nop 0
    buffer_load_dwordx4 v5, s[44:47], s77 offen lds
    v_exp_f32 v48, v48
    v_exp_f32 v45, v45
    buffer_load_dwordx4 v6, s[44:47], s77 offen offset:1024 lds
    s_add_u32 s77, s77, 65536
    v_exp_f32 v49, v49
    v_exp_f32 v46, v46
    s_add_u32 m0, s78, 10240
    s_nop 0
    buffer_load_dwordx4 v5, s[44:47], s77 offen lds
    v_exp_f32 v50, v50
    v_exp_f32 v47, v47
    buffer_load_dwordx4 v6, s[44:47], s77 offen offset:1024 lds
    s_add_u32 s77, s77, 65536
    v_exp_f32 v51, v51
    v_pk_mul_f32 v[208:209], v[208:209], v[192:193]
    s_add_u32 m0, s78, 12288
    s_nop 0
    buffer_load_dwordx4 v5, s[44:47], s77 offen lds
    v_pk_mul_f32 v[240:241], v[240:241], v[224:225]
    v_pk_mul_f32 v[210:211], v[210:211], v[194:195]
    v_pk_mul_f32 v[242:243], v[242:243], v[226:227]
    buffer_load_dwordx4 v6, s[44:47], s77 offen offset:1024 lds
    s_add_u32 s77, s77, 65536
    v_pk_fma_f32 v[44:45], v[44:45], v[38:39], v[38:39] op_sel_hi:[1,0,0]
    v_pk_fma_f32 v[48:49], v[48:49], v[42:43], v[42:43] op_sel_hi:[1,0,0]
    s_add_u32 m0, s78, 14336
    s_nop 0
    buffer_load_dwordx4 v5, s[44:47], s77 offen lds
    v_pk_fma_f32 v[46:47], v[46:47], v[38:39], v[38:39] op_sel_hi:[1,0,0]
    v_pk_fma_f32 v[50:51], v[50:51], v[42:43], v[42:43] op_sel_hi:[1,0,0]
    buffer_load_dwordx4 v6, s[44:47], s77 offen offset:1024 lds
    s_add_u32 s77, s77, 65536
    v_rcp_f32 v44, v44
    v_rcp_f32 v48, v48
    s_add_u32 m0, s78, 16384
    s_nop 0
    buffer_load_dwordx4 v5, s[44:47], s77 offen lds
    v_rcp_f32 v45, v45
    v_rcp_f32 v49, v49
    buffer_load_dwordx4 v6, s[44:47], s77 offen offset:1024 lds
    s_add_u32 s77, s77, 65536
    v_rcp_f32 v46, v46
    v_rcp_f32 v50, v50
    s_add_u32 m0, s78, 18432
    s_nop 0
    buffer_load_dwordx4 v5, s[44:47], s77 offen lds
    v_rcp_f32 v47, v47
    v_rcp_f32 v51, v51
    v_pk_mul_f32 v[208:209], v[208:209], v[44:45]
    buffer_load_dwordx4 v6, s[44:47], s77 offen offset:1024 lds
    s_add_u32 s77, s77, 65536
    v_pk_mul_f32 v[240:241], v[240:241], v[48:49]
    v_pk_mul_f32 v[210:211], v[210:211], v[46:47]
    s_add_u32 m0, s78, 20480
    s_nop 0
    buffer_load_dwordx4 v5, s[44:47], s77 offen lds
    v_pk_mul_f32 v[242:243], v[242:243], v[50:51]
    v_cvt_pk_bf16_f32 v192, v208, v209
    buffer_load_dwordx4 v6, s[44:47], s77 offen offset:1024 lds
    s_add_u32 s77, s77, 65536
    v_cvt_pk_bf16_f32 v224, v240, v241
    v_cvt_pk_bf16_f32 v193, v210, v211
    s_add_u32 m0, s78, 22528
    s_nop 0
    buffer_load_dwordx4 v5, s[44:47], s77 offen lds
    v_cvt_pk_bf16_f32 v225, v242, v243
    v_pk_mul_f32 v[44:45], v[196:197], v[196:197]
    buffer_load_dwordx4 v6, s[44:47], s77 offen offset:1024 lds
    s_add_u32 s77, s77, 65536
    v_pk_mul_f32 v[48:49], v[228:229], v[228:229]
    v_pk_mul_f32 v[46:47], v[198:199], v[198:199]
    s_add_u32 m0, s78, 24576
    s_nop 0
    buffer_load_dwordx4 v5, s[44:47], s77 offen lds
    v_pk_mul_f32 v[50:51], v[230:231], v[230:231]
    v_pk_fma_f32 v[44:45], v[44:45], v[36:37], v[36:37] op_sel:[0,1,0] op_sel_hi:[1,1,0]
    v_pk_fma_f32 v[48:49], v[48:49], v[40:41], v[40:41] op_sel:[0,1,0] op_sel_hi:[1,1,0]
    buffer_load_dwordx4 v6, s[44:47], s77 offen offset:1024 lds
    s_add_u32 s77, s77, 65536
    v_pk_fma_f32 v[46:47], v[46:47], v[36:37], v[36:37] op_sel:[0,1,0] op_sel_hi:[1,1,0]
    v_pk_fma_f32 v[50:51], v[50:51], v[40:41], v[40:41] op_sel:[0,1,0] op_sel_hi:[1,1,0]
    s_add_u32 m0, s78, 26624
    s_nop 0
    buffer_load_dwordx4 v5, s[44:47], s77 offen lds
    v_pk_mul_f32 v[44:45], v[44:45], v[196:197]
    v_pk_mul_f32 v[48:49], v[48:49], v[228:229]
    buffer_load_dwordx4 v6, s[44:47], s77 offen offset:1024 lds
    s_add_u32 s77, s77, 65536
    v_pk_mul_f32 v[46:47], v[46:47], v[198:199]
    v_pk_mul_f32 v[50:51], v[50:51], v[230:231]
    s_add_u32 m0, s78, 28672
    s_nop 0
    buffer_load_dwordx4 v5, s[44:47], s77 offen lds
    v_exp_f32 v44, v44
    v_exp_f32 v48, v48
    buffer_load_dwordx4 v6, s[44:47], s77 offen offset:1024 lds
    s_add_u32 s77, s77, 65536
    v_exp_f32 v45, v45
    v_exp_f32 v49, v49
    s_add_u32 m0, s78, 30720
    s_nop 0
    buffer_load_dwordx4 v5, s[44:47], s77 offen lds
    v_exp_f32 v46, v46
    v_exp_f32 v50, v50
    v_exp_f32 v47, v47
    buffer_load_dwordx4 v6, s[44:47], s77 offen offset:1024 lds
    s_add_u32 s77, s77, 65536
    v_exp_f32 v51, v51
    v_pk_mul_f32 v[212:213], v[212:213], v[196:197]
    v_bfe_u32 v26, v1, 2, 2
    v_pk_mul_f32 v[244:245], v[244:245], v[228:229]
    v_pk_mul_f32 v[214:215], v[214:215], v[198:199]
    v_bfe_u32 v4, v1, 5, 1
    v_pk_mul_f32 v[246:247], v[246:247], v[230:231]
    v_pk_fma_f32 v[44:45], v[44:45], v[38:39], v[38:39] op_sel_hi:[1,0,0]
    v_lshl_add_u32 v26, v4, 2, v26
    v_pk_fma_f32 v[48:49], v[48:49], v[42:43], v[42:43] op_sel_hi:[1,0,0]
    v_pk_fma_f32 v[46:47], v[46:47], v[38:39], v[38:39] op_sel_hi:[1,0,0]
    v_lshlrev_b32 v26, 7, v26
    v_pk_fma_f32 v[50:51], v[50:51], v[42:43], v[42:43] op_sel_hi:[1,0,0]
    v_rcp_f32 v44, v44
    v_bfe_u32 v4, v1, 4, 1
    v_rcp_f32 v48, v48
    v_rcp_f32 v45, v45
    v_rcp_f32 v49, v49
    v_lshlrev_b32 v4, 1, v4
    v_rcp_f32 v46, v46
    v_rcp_f32 v50, v50
    v_bfe_u32 v10, v1, 1, 1
    v_rcp_f32 v47, v47
    v_rcp_f32 v51, v51
    v_add_u32 v4, v4, v10
    v_pk_mul_f32 v[212:213], v[212:213], v[44:45]
    v_pk_mul_f32 v[244:245], v[244:245], v[48:49]
    v_bfe_u32 v10, v1, 3, 1
    v_pk_mul_f32 v[214:215], v[214:215], v[46:47]
    v_pk_mul_f32 v[246:247], v[246:247], v[50:51]
    v_lshlrev_b32 v10, 2, v10
    v_cvt_pk_bf16_f32 v194, v212, v213
    v_cvt_pk_bf16_f32 v226, v244, v245
    v_xor_b32 v4, v4, v10
    v_cvt_pk_bf16_f32 v195, v214, v215
    v_cvt_pk_bf16_f32 v227, v246, v247
    buffer_store_dwordx4 v[192:195], v27, s[52:55], s82 offen offset:0 sc1
    v_lshl_add_u32 v26, v4, 4, v26
    buffer_store_dwordx4 v[224:227], v27, s[56:59], s82 offen offset:0 sc1
    v_pk_mul_f32 v[44:45], v[200:201], v[200:201]
    v_and_b32 v4, 1, v1
    v_pk_mul_f32 v[48:49], v[232:233], v[232:233]
    v_pk_mul_f32 v[46:47], v[202:203], v[202:203]
    v_lshl_add_u32 v26, v4, 3, v26
    v_pk_mul_f32 v[50:51], v[234:235], v[234:235]
    v_pk_fma_f32 v[44:45], v[44:45], v[36:37], v[36:37] op_sel:[0,1,0] op_sel_hi:[1,1,0]
    v_add_u32 v9, s78, v26
    v_pk_fma_f32 v[48:49], v[48:49], v[40:41], v[40:41] op_sel:[0,1,0] op_sel_hi:[1,1,0]
    v_pk_fma_f32 v[46:47], v[46:47], v[36:37], v[36:37] op_sel:[0,1,0] op_sel_hi:[1,1,0]
    v_xor_b32 v10, 64, v9
    v_pk_fma_f32 v[50:51], v[50:51], v[40:41], v[40:41] op_sel:[0,1,0] op_sel_hi:[1,1,0]
    v_pk_mul_f32 v[44:45], v[44:45], v[200:201]
    s_bitcmp1_b32 s5, 0
    s_cselect_b32 s48, s20, s18
    s_cselect_b32 s49, s21, s19
    v_pk_mul_f32 v[48:49], v[48:49], v[232:233]
    v_pk_mul_f32 v[46:47], v[46:47], v[202:203]
    s_mov_b32 s50, 524288
    v_pk_mul_f32 v[50:51], v[50:51], v[234:235]
    v_exp_f32 v44, v44
    v_exp_f32 v48, v48
    s_mov_b32 s51, 0x20000
    v_exp_f32 v45, v45
    v_exp_f32 v49, v49
    v_and_b32 v4, 7, v1
    v_exp_f32 v46, v46
    v_exp_f32 v50, v50
    v_lshrrev_b32 v26, 4, v1
    v_exp_f32 v47, v47
    v_exp_f32 v51, v51
    v_xor_b32 v4, v4, v26
    v_pk_mul_f32 v[216:217], v[216:217], v[200:201]
    v_pk_mul_f32 v[248:249], v[248:249], v[232:233]
    v_lshlrev_b32 v4, 4, v4
    v_pk_mul_f32 v[218:219], v[218:219], v[202:203]
    v_pk_mul_f32 v[250:251], v[250:251], v[234:235]
    v_lshrrev_b32 v26, 3, v1
    v_pk_fma_f32 v[44:45], v[44:45], v[38:39], v[38:39] op_sel_hi:[1,0,0]
    v_pk_fma_f32 v[48:49], v[48:49], v[42:43], v[42:43] op_sel_hi:[1,0,0]
    v_pk_fma_f32 v[46:47], v[46:47], v[38:39], v[38:39] op_sel_hi:[1,0,0]
    v_lshl_add_u32 v11, v26, 10, v4
    v_pk_fma_f32 v[50:51], v[50:51], v[42:43], v[42:43] op_sel_hi:[1,0,0]
    v_rcp_f32 v44, v44
    v_xor_b32 v12, 64, v11
    v_rcp_f32 v48, v48
    v_rcp_f32 v45, v45
    v_add_u32 v13, 14336, v11
    v_rcp_f32 v49, v49
    v_rcp_f32 v46, v46
    v_add_u32 v14, 21504, v12
    v_rcp_f32 v50, v50
    v_rcp_f32 v47, v47
    v_add_u32 v12, 7168, v12
    v_rcp_f32 v51, v51
    v_pk_mul_f32 v[216:217], v[216:217], v[44:45]
    s_and_b32 s76, s4, 7
    v_pk_mul_f32 v[248:249], v[248:249], v[48:49]
    v_pk_mul_f32 v[218:219], v[218:219], v[46:47]
    v_pk_mul_f32 v[250:251], v[250:251], v[50:51]
    s_lshl_b32 s79, s76, 16
    v_cvt_pk_bf16_f32 v200, v216, v217
    v_cvt_pk_bf16_f32 v232, v248, v249
    s_lshr_b32 s99, s5, 1
    v_cvt_pk_bf16_f32 v201, v218, v219
    v_cvt_pk_bf16_f32 v233, v250, v251
    s_lshl_b32 s99, s99, 7
    v_pk_mul_f32 v[44:45], v[204:205], v[204:205]
    v_pk_mul_f32 v[48:49], v[236:237], v[236:237]
    s_add_u32 s79, s79, s99
    v_pk_mul_f32 v[46:47], v[206:207], v[206:207]
    v_pk_mul_f32 v[50:51], v[238:239], v[238:239]
    v_and_b32 v26, 31, v1
    v_pk_fma_f32 v[44:45], v[44:45], v[36:37], v[36:37] op_sel:[0,1,0] op_sel_hi:[1,1,0]
    v_pk_fma_f32 v[48:49], v[48:49], v[40:41], v[40:41] op_sel:[0,1,0] op_sel_hi:[1,1,0]
    v_lshrrev_b32 v4, 5, v1
    v_pk_fma_f32 v[46:47], v[46:47], v[36:37], v[36:37] op_sel:[0,1,0] op_sel_hi:[1,1,0]
    v_pk_fma_f32 v[50:51], v[50:51], v[40:41], v[40:41] op_sel:[0,1,0] op_sel_hi:[1,1,0]
    v_pk_mul_f32 v[44:45], v[44:45], v[204:205]
    v_bfe_u32 v25, v26, 1, 3
    v_pk_mul_f32 v[48:49], v[48:49], v[236:237]
    v_pk_mul_f32 v[46:47], v[46:47], v[206:207]
    v_lshlrev_b32 v26, 7, v26
    v_pk_mul_f32 v[50:51], v[50:51], v[238:239]
    v_exp_f32 v44, v44
    v_or_b32 v15, 0, v4
    v_exp_f32 v48, v48
    v_exp_f32 v45, v45
    v_xor_b32 v15, v15, v25
    v_exp_f32 v49, v49
    v_exp_f32 v46, v46
    v_lshl_add_u32 v15, v15, 4, v26
    v_exp_f32 v50, v50
    v_exp_f32 v47, v47
    v_or_b32 v16, 2, v4
    v_exp_f32 v51, v51
    v_pk_mul_f32 v[220:221], v[220:221], v[204:205]
    v_pk_mul_f32 v[252:253], v[252:253], v[236:237]
    v_xor_b32 v16, v16, v25
    v_pk_mul_f32 v[222:223], v[222:223], v[206:207]
    v_pk_mul_f32 v[254:255], v[254:255], v[238:239]
    v_lshl_add_u32 v16, v16, 4, v26
    v_pk_fma_f32 v[44:45], v[44:45], v[38:39], v[38:39] op_sel_hi:[1,0,0]
    v_pk_fma_f32 v[48:49], v[48:49], v[42:43], v[42:43] op_sel_hi:[1,0,0]
    v_or_b32 v24, 4, v4
    v_pk_fma_f32 v[46:47], v[46:47], v[38:39], v[38:39] op_sel_hi:[1,0,0]
    v_pk_fma_f32 v[50:51], v[50:51], v[42:43], v[42:43] op_sel_hi:[1,0,0]
    v_xor_b32 v24, v24, v25
    v_rcp_f32 v44, v44
    v_rcp_f32 v48, v48
    v_lshl_add_u32 v24, v24, 4, v26
    v_rcp_f32 v45, v45
    v_rcp_f32 v49, v49
    v_or_b32 v4, 6, v4
    v_rcp_f32 v46, v46
    v_rcp_f32 v50, v50
    v_rcp_f32 v47, v47
    v_xor_b32 v25, v4, v25
    v_rcp_f32 v51, v51
    v_pk_mul_f32 v[220:221], v[220:221], v[44:45]
    v_lshl_add_u32 v25, v25, 4, v26
    v_pk_mul_f32 v[252:253], v[252:253], v[48:49]
    v_pk_mul_f32 v[222:223], v[222:223], v[46:47]
    v_add_u32 v15, s78, v15
    v_pk_mul_f32 v[254:255], v[254:255], v[50:51]
    v_cvt_pk_bf16_f32 v202, v220, v221
    v_add_u32 v16, s78, v16
    v_cvt_pk_bf16_f32 v234, v252, v253
    v_cvt_pk_bf16_f32 v203, v222, v223
    v_add_u32 v24, s78, v24
    v_cvt_pk_bf16_f32 v235, v254, v255
    buffer_store_dwordx4 v[200:203], v27, s[52:55], s82 offen offset:1024 sc1
    v_add_u32 v25, s78, v25
    buffer_store_dwordx4 v[232:235], v27, s[56:59], s82 offen offset:1024 sc1
L_p1_fin:
s_waitcnt vmcnt(0)
s_barrier
s_mov_b32 s98, s85
s_cmp_lg_u32 s5, 0
s_cbranch_scc1 L_f_fskip
v_mov_b32 v36, s98
v_mov_b32 v37, s98
s_lshl_b32 s95, s3, 4
s_add_u32 s95, s95, s4
s_lshl_b32 s95, s95, 3
s_add_u32 s95, s95, 393216
s_mov_b64 exec, 1
buffer_store_dwordx2 v[36:37], off, s[60:63], s95 sc1
s_mov_b64 exec, -1
L_f_fskip:
    ds_read_b64_tr_b16 a[0:1], v9 offset:0
    ds_read_b64_tr_b16 a[2:3], v9 offset:1024
    ds_read_b64_tr_b16 a[4:5], v10 offset:0
    ds_read_b64_tr_b16 a[6:7], v10 offset:1024
    ds_read_b64_tr_b16 a[8:9], v9 offset:2048
    ds_read_b64_tr_b16 a[10:11], v9 offset:3072
    ds_read_b64_tr_b16 a[12:13], v10 offset:2048
    ds_read_b64_tr_b16 a[14:15], v10 offset:3072
    ds_read_b64_tr_b16 a[16:17], v9 offset:4096
    ds_read_b64_tr_b16 a[18:19], v9 offset:5120
    ds_read_b64_tr_b16 a[20:21], v10 offset:4096
    ds_read_b64_tr_b16 a[22:23], v10 offset:5120
    ds_read_b64_tr_b16 a[24:25], v9 offset:6144
    ds_read_b64_tr_b16 a[26:27], v9 offset:7168
    ds_read_b64_tr_b16 a[28:29], v10 offset:6144
    ds_read_b64_tr_b16 a[30:31], v10 offset:7168
    ds_read_b64_tr_b16 a[32:33], v9 offset:8192
    ds_read_b64_tr_b16 a[34:35], v9 offset:9216
    ds_read_b64_tr_b16 a[36:37], v10 offset:8192
    ds_read_b64_tr_b16 a[38:39], v10 offset:9216
    ds_read_b64_tr_b16 a[40:41], v9 offset:10240
    ds_read_b64_tr_b16 a[42:43], v9 offset:11264
    ds_read_b64_tr_b16 a[44:45], v10 offset:10240
    ds_read_b64_tr_b16 a[46:47], v10 offset:11264
    ds_read_b64_tr_b16 a[48:49], v9 offset:12288
    ds_read_b64_tr_b16 a[50:51], v9 offset:13312
    ds_read_b64_tr_b16 a[52:53], v10 offset:12288
    ds_read_b64_tr_b16 a[54:55], v10 offset:13312
    ds_read_b64_tr_b16 a[56:57], v9 offset:14336
    ds_read_b64_tr_b16 a[58:59], v9 offset:15360
    ds_read_b64_tr_b16 a[60:61], v10 offset:14336
    ds_read_b64_tr_b16 a[62:63], v10 offset:15360
    ds_read_b64_tr_b16 a[64:65], v9 offset:16384
    ds_read_b64_tr_b16 a[66:67], v9 offset:17408
    ds_read_b64_tr_b16 a[68:69], v10 offset:16384
    ds_read_b64_tr_b16 a[70:71], v10 offset:17408
    ds_read_b64_tr_b16 a[72:73], v9 offset:18432
    ds_read_b64_tr_b16 a[74:75], v9 offset:19456
    ds_read_b64_tr_b16 a[76:77], v10 offset:18432
    ds_read_b64_tr_b16 a[78:79], v10 offset:19456
    ds_read_b64_tr_b16 a[80:81], v9 offset:20480
    ds_read_b64_tr_b16 a[82:83], v9 offset:21504
    ds_read_b64_tr_b16 a[84:85], v10 offset:20480
    ds_read_b64_tr_b16 a[86:87], v10 offset:21504
    ds_read_b64_tr_b16 a[88:89], v9 offset:22528
    ds_read_b64_tr_b16 a[90:91], v9 offset:23552
    ds_read_b64_tr_b16 a[92:93], v10 offset:22528
    ds_read_b64_tr_b16 a[94:95], v10 offset:23552
    ds_read_b64_tr_b16 a[96:97], v9 offset:24576
    ds_read_b64_tr_b16 a[98:99], v9 offset:25600
    ds_read_b64_tr_b16 a[100:101], v10 offset:24576
    ds_read_b64_tr_b16 a[102:103], v10 offset:25600
    ds_read_b64_tr_b16 a[104:105], v9 offset:26624
    ds_read_b64_tr_b16 a[106:107], v9 offset:27648
    ds_read_b64_tr_b16 a[108:109], v10 offset:26624
    ds_read_b64_tr_b16 a[110:111], v10 offset:27648
    ds_read_b64_tr_b16 a[112:113], v9 offset:28672
    ds_read_b64_tr_b16 a[114:115], v9 offset:29696
    ds_read_b64_tr_b16 a[116:117], v10 offset:28672
    ds_read_b64_tr_b16 a[118:119], v10 offset:29696
    ds_read_b64_tr_b16 a[120:121], v9 offset:30720
    ds_read_b64_tr_b16 a[122:123], v9 offset:31744
    ds_read_b64_tr_b16 a[124:125], v10 offset:30720
    ds_read_b64_tr_b16 a[126:127], v10 offset:31744
    s_waitcnt lgkmcnt(0)
    s_add_u32 m0, s78, 0
    s_nop 0
    buffer_load_dwordx4 v5, s[44:47], s77 offen lds
    buffer_load_dwordx4 v6, s[44:47], s77 offen offset:1024 lds
    s_add_u32 s77, s77, 65536
    s_add_u32 m0, s78, 2048
    s_nop 0
    buffer_load_dwordx4 v5, s[44:47], s77 offen lds
    buffer_load_dwordx4 v6, s[44:47], s77 offen offset:1024 lds
    s_add_u32 s77, s77, 65536
    s_add_u32 m0, s78, 4096
    s_nop 0
    buffer_load_dwordx4 v5, s[44:47], s77 offen lds
    buffer_load_dwordx4 v6, s[44:47], s77 offen offset:1024 lds
    s_add_u32 s77, s77, 65536
    s_add_u32 m0, s78, 6144
    s_nop 0
    buffer_load_dwordx4 v5, s[44:47], s77 offen lds
    buffer_load_dwordx4 v6, s[44:47], s77 offen offset:1024 lds
    s_add_u32 s77, s77, 65536
    s_add_u32 m0, s78, 8192
    s_nop 0
    buffer_load_dwordx4 v5, s[44:47], s77 offen lds
    buffer_load_dwordx4 v6, s[44:47], s77 offen offset:1024 lds
    s_add_u32 s77, s77, 65536
    s_add_u32 m0, s78, 10240
    s_nop 0
    buffer_load_dwordx4 v5, s[44:47], s77 offen lds
    buffer_load_dwordx4 v6, s[44:47], s77 offen offset:1024 lds
    s_add_u32 s77, s77, 65536
    s_add_u32 m0, s78, 16384
    s_nop 0
    buffer_load_dwordx4 v11, s[48:51], s79 offen offset:0 lds
    buffer_load_dwordx4 v12, s[48:51], s79 offen offset:1024 lds
    buffer_load_dwordx4 v13, s[48:51], s79 offen offset:2048 lds
    buffer_load_dwordx4 v14, s[48:51], s79 offen offset:3072 lds
    s_add_u32 m0, s78, 20480
    s_add_u32 s99, s79, 32768
    buffer_load_dwordx4 v11, s[48:51], s99 offen offset:0 lds
    buffer_load_dwordx4 v12, s[48:51], s99 offen offset:1024 lds
    buffer_load_dwordx4 v13, s[48:51], s99 offen offset:2048 lds
    buffer_load_dwordx4 v14, s[48:51], s99 offen offset:3072 lds
    s_add_u32 s79, s79, 256
    s_add_u32 m0, s78, 24576
    s_nop 0
    buffer_load_dwordx4 v11, s[48:51], s79 offen offset:0 lds
    buffer_load_dwordx4 v12, s[48:51], s79 offen offset:1024 lds
    buffer_load_dwordx4 v13, s[48:51], s79 offen offset:2048 lds
    buffer_load_dwordx4 v14, s[48:51], s79 offen offset:3072 lds
    s_add_u32 m0, s78, 28672
    s_add_u32 s99, s79, 32768
    buffer_load_dwordx4 v11, s[48:51], s99 offen offset:0 lds
    buffer_load_dwordx4 v12, s[48:51], s99 offen offset:1024 lds
    buffer_load_dwordx4 v13, s[48:51], s99 offen offset:2048 lds
    buffer_load_dwordx4 v14, s[48:51], s99 offen offset:3072 lds
    s_add_u32 s79, s79, 256
    s_waitcnt vmcnt(0)
    ds_read_b64_tr_b16 a[128:129], v9 offset:0
    ds_read_b64_tr_b16 a[130:131], v9 offset:1024
    ds_read_b64_tr_b16 a[132:133], v10 offset:0
    ds_read_b64_tr_b16 a[134:135], v10 offset:1024
    ds_read_b64_tr_b16 a[136:137], v9 offset:2048
    ds_read_b64_tr_b16 a[138:139], v9 offset:3072
    ds_read_b64_tr_b16 a[140:141], v10 offset:2048
    ds_read_b64_tr_b16 a[142:143], v10 offset:3072
    ds_read_b64_tr_b16 a[144:145], v9 offset:4096
    ds_read_b64_tr_b16 a[146:147], v9 offset:5120
    ds_read_b64_tr_b16 a[148:149], v10 offset:4096
    ds_read_b64_tr_b16 a[150:151], v10 offset:5120
    ds_read_b64_tr_b16 a[152:153], v9 offset:6144
    ds_read_b64_tr_b16 a[154:155], v9 offset:7168
    ds_read_b64_tr_b16 a[156:157], v10 offset:6144
    ds_read_b64_tr_b16 a[158:159], v10 offset:7168
    ds_read_b64_tr_b16 a[160:161], v9 offset:8192
    ds_read_b64_tr_b16 a[162:163], v9 offset:9216
    ds_read_b64_tr_b16 a[164:165], v10 offset:8192
    ds_read_b64_tr_b16 a[166:167], v10 offset:9216
    ds_read_b64_tr_b16 a[168:169], v9 offset:10240
    ds_read_b64_tr_b16 a[170:171], v9 offset:11264
    ds_read_b64_tr_b16 a[172:173], v10 offset:10240
    ds_read_b64_tr_b16 a[174:175], v10 offset:11264
    s_waitcnt lgkmcnt(0)
    s_add_u32 m0, s78, 0
    s_nop 0
    buffer_load_dwordx4 v11, s[48:51], s79 offen offset:0 lds
    buffer_load_dwordx4 v12, s[48:51], s79 offen offset:1024 lds
    buffer_load_dwordx4 v13, s[48:51], s79 offen offset:2048 lds
    buffer_load_dwordx4 v14, s[48:51], s79 offen offset:3072 lds
    s_add_u32 m0, s78, 4096
    s_add_u32 s99, s79, 32768
    buffer_load_dwordx4 v11, s[48:51], s99 offen offset:0 lds
    buffer_load_dwordx4 v12, s[48:51], s99 offen offset:1024 lds
    buffer_load_dwordx4 v13, s[48:51], s99 offen offset:2048 lds
    buffer_load_dwordx4 v14, s[48:51], s99 offen offset:3072 lds
    s_add_u32 s79, s79, 256
    s_add_u32 m0, s78, 8192
    s_nop 0
    buffer_load_dwordx4 v11, s[48:51], s79 offen offset:0 lds
    buffer_load_dwordx4 v12, s[48:51], s79 offen offset:1024 lds
    buffer_load_dwordx4 v13, s[48:51], s79 offen offset:2048 lds
    buffer_load_dwordx4 v14, s[48:51], s79 offen offset:3072 lds
    s_add_u32 m0, s78, 12288
    s_add_u32 s99, s79, 32768
    buffer_load_dwordx4 v11, s[48:51], s99 offen offset:0 lds
    buffer_load_dwordx4 v12, s[48:51], s99 offen offset:1024 lds
    buffer_load_dwordx4 v13, s[48:51], s99 offen offset:2048 lds
    buffer_load_dwordx4 v14, s[48:51], s99 offen offset:3072 lds
    s_add_u32 s79, s79, 256
    s_lshr_b32 s92, s4, 3
    s_lshl_b32 s88, s3, 1
    s_add_u32 s88, s88, s92
    s_and_b32 s89, s4, 7
    s_mul_i32 s92, s88, 307200
    s_add_u32 s52, s38, s92
    s_addc_u32 s53, s39, 0
    s_mov_b32 s54, 88064
    s_mov_b32 s55, 0x20000
    s_add_u32 s92, s92, 153600
    s_add_u32 s56, s38, s92
    s_addc_u32 s57, s39, 0
    s_mov_b32 s58, 88064
    s_mov_b32 s59, 0x20000
    v_lshlrev_b32 v8, 4, v1
    s_lshl_b32 s90, s5, 10
    v_lshrrev_b32 v11, 4, v1
    s_lshl_b32 s92, s5, 4
    v_add_u32 v11, s92, v11
    v_and_b32 v12, 15, v1
    s_lshl_b32 s92, s88, 6
    v_add_u32 v13, s92, v11
    s_lshl_b32 s92, s89, 7
    v_lshlrev_b32 v14, 10, v13
    v_lshl_add_u32 v14, v12, 3, v14
    v_add_u32 v14, s92, v14
    v_lshlrev_b32 v17, 4, v13
    v_lshlrev_b32 v26, 3, v12
    v_add_u32 v26, s92, v26
    s_mov_b32 s64, s8
    s_mov_b32 s65, s9
    s_mov_b32 s66, 2097152
    s_mov_b32 s67, 0x20000
    s_mov_b32 s68, s24
    s_mov_b32 s69, s25
    s_mov_b32 s70, 1024
    s_mov_b32 s71, 0x20000
    s_mov_b32 s72, s34
    s_mov_b32 s73, s35
    s_mov_b32 s74, 4194304
    s_mov_b32 s75, 0x20000
    s_add_u32 s40, s38, 13631488
    s_addc_u32 s41, s39, 0
    s_mov_b32 s42, 32768
    s_mov_b32 s43, 0x20000
    s_mov_b32 s84, 0
    s_movk_i32 s85, 4096
    s_movk_i32 s86, 8192
    s_movk_i32 s87, 12288
    buffer_load_dwordx2 v[28:29], v14, s[64:67], s84 offen
    buffer_load_dwordx2 v[30:31], v14, s[64:67], s85 offen
    buffer_load_dwordx2 v[32:33], v14, s[64:67], s86 offen
    buffer_load_dwordx2 v[34:35], v14, s[64:67], s87 offen
    buffer_load_dwordx2 v[44:45], v26, s[68:71], 0 offen
    buffer_load_dword v36, v17, s[40:43], 0 offen offset:0 sc1
    buffer_load_dword v37, v17, s[40:43], 0 offen offset:8 sc1
    buffer_load_dword v38, v17, s[40:43], 0 offen offset:64 sc1
    buffer_load_dword v39, v17, s[40:43], 0 offen offset:72 sc1
    buffer_load_dword v40, v17, s[40:43], 0 offen offset:128 sc1
    buffer_load_dword v41, v17, s[40:43], 0 offen offset:136 sc1
    buffer_load_dword v42, v17, s[40:43], 0 offen offset:192 sc1
    buffer_load_dword v43, v17, s[40:43], 0 offen offset:200 sc1
s_cmp_lg_u32 s5, 0
s_cbranch_scc1 L_f_pskip
v_lshlrev_b32 v46, 3, v1
s_lshl_b32 s95, s3, 7
s_add_u32 s95, s95, 393216
s_mov_b32 s94, 400000
s_mov_b64 exec, 0xffff
L_f_poll:
buffer_load_dwordx2 v[48:49], v46, s[60:63], s95 offen sc1
s_waitcnt vmcnt(0)
v_xor_b32 v48, s98, v48
v_xor_b32 v49, s98, v49
v_or_b32 v48, v48, v49
v_cmp_ne_u32 vcc, 0, v48
s_nop 4
s_cbranch_vccz L_f_pok
s_sleep 1
s_sub_u32 s94, s94, 1
s_cmp_lg_u32 s94, 0
s_cbranch_scc1 L_f_poll
L_f_pok:
s_mov_b64 exec, -1
L_f_pskip:
s_barrier
    buffer_load_dwordx4 v[128:131], v8, s[52:55], s90 offen sc1
    buffer_load_dwordx4 v[132:135], v8, s[56:59], s90 offen sc1
    s_add_u32 s90, s90, 4096
    buffer_load_dwordx4 v[136:139], v8, s[52:55], s90 offen sc1
    buffer_load_dwordx4 v[140:143], v8, s[56:59], s90 offen sc1
    s_add_u32 s90, s90, 4096
    buffer_load_dwordx4 v[144:147], v8, s[52:55], s90 offen sc1
    buffer_load_dwordx4 v[148:151], v8, s[56:59], s90 offen sc1
    s_add_u32 s90, s90, 4096
    buffer_load_dwordx4 v[152:155], v8, s[52:55], s90 offen sc1
    buffer_load_dwordx4 v[156:159], v8, s[56:59], s90 offen sc1
    s_add_u32 s90, s90, 4096
    buffer_load_dwordx4 v[160:163], v8, s[52:55], s90 offen sc1
    buffer_load_dwordx4 v[164:167], v8, s[56:59], s90 offen sc1
    s_add_u32 s90, s90, 4096
    buffer_load_dwordx4 v[168:171], v8, s[52:55], s90 offen sc1
    buffer_load_dwordx4 v[172:175], v8, s[56:59], s90 offen sc1
    s_add_u32 s90, s90, 4096
    buffer_load_dwordx4 v[176:179], v8, s[52:55], s90 offen sc1
    buffer_load_dwordx4 v[180:183], v8, s[56:59], s90 offen sc1
    s_add_u32 s90, s90, 4096
    buffer_load_dwordx4 v[184:187], v8, s[52:55], s90 offen sc1
    buffer_load_dwordx4 v[188:191], v8, s[56:59], s90 offen sc1
    s_add_u32 s90, s90, 4096
    s_waitcnt vmcnt(15)
    v_mfma_f32_32x32x16_bf16 v[64:79], a[0:3], v[128:131], 0
    buffer_load_dwordx4 v[192:195], v8, s[52:55], s90 offen sc1
    buffer_load_dwordx4 v[196:199], v8, s[56:59], s90 offen sc1
    s_add_u32 s90, s90, 4096
    s_waitcnt vmcnt(16)
    v_mfma_f32_32x32x16_bf16 v[80:95], a[0:3], v[132:135], 0
    buffer_load_dwordx4 v[200:203], v8, s[52:55], s90 offen sc1
    buffer_load_dwordx4 v[204:207], v8, s[56:59], s90 offen sc1
    s_add_u32 s90, s90, 4096
    v_mfma_f32_32x32x16_bf16 v[96:111], a[4:7], v[128:131], 0
    v_mfma_f32_32x32x16_bf16 v[112:127], a[4:7], v[132:135], 0
    s_waitcnt vmcnt(17)
    v_mfma_f32_32x32x16_bf16 v[64:79], a[8:11], v[136:139], v[64:79]
    buffer_load_dwordx4 v[208:211], v8, s[52:55], s90 offen sc1
    buffer_load_dwordx4 v[212:215], v8, s[56:59], s90 offen sc1
    s_add_u32 s90, s90, 4096
    s_waitcnt vmcnt(18)
    v_mfma_f32_32x32x16_bf16 v[80:95], a[8:11], v[140:143], v[80:95]
    buffer_load_dwordx4 v[216:219], v8, s[52:55], s90 offen sc1
    buffer_load_dwordx4 v[220:223], v8, s[56:59], s90 offen sc1
    s_add_u32 s90, s90, 4096
    v_mfma_f32_32x32x16_bf16 v[96:111], a[12:15], v[136:139], v[96:111]
    v_mfma_f32_32x32x16_bf16 v[112:127], a[12:15], v[140:143], v[112:127]
    s_waitcnt vmcnt(19)
    v_mfma_f32_32x32x16_bf16 v[64:79], a[16:19], v[144:147], v[64:79]
    buffer_load_dwordx4 v[224:227], v8, s[52:55], s90 offen sc1
    buffer_load_dwordx4 v[228:231], v8, s[56:59], s90 offen sc1
    s_add_u32 s90, s90, 4096
    s_waitcnt vmcnt(20)
    v_mfma_f32_32x32x16_bf16 v[80:95], a[16:19], v[148:151], v[80:95]
    buffer_load_dwordx4 v[232:235], v8, s[52:55], s90 offen sc1
    buffer_load_dwordx4 v[236:239], v8, s[56:59], s90 offen sc1
    s_add_u32 s90, s90, 4096
    v_mfma_f32_32x32x16_bf16 v[96:111], a[20:23], v[144:147], v[96:111]
    v_mfma_f32_32x32x16_bf16 v[112:127], a[20:23], v[148:151], v[112:127]
    s_waitcnt vmcnt(21)
    v_mfma_f32_32x32x16_bf16 v[64:79], a[24:27], v[152:155], v[64:79]
    buffer_load_dwordx4 a[176:179], v8, s[52:55], s90 offen sc1
    buffer_load_dwordx4 a[180:183], v8, s[56:59], s90 offen sc1
    s_add_u32 s90, s90, 4096
    s_waitcnt vmcnt(22)
    v_mfma_f32_32x32x16_bf16 v[80:95], a[24:27], v[156:159], v[80:95]
    buffer_load_dwordx4 a[184:187], v8, s[52:55], s90 offen sc1
    buffer_load_dwordx4 a[188:191], v8, s[56:59], s90 offen sc1
    s_add_u32 s90, s90, 4096
    v_mfma_f32_32x32x16_bf16 v[96:111], a[28:31], v[152:155], v[96:111]
    v_mfma_f32_32x32x16_bf16 v[112:127], a[28:31], v[156:159], v[112:127]
    s_waitcnt vmcnt(23)
    v_mfma_f32_32x32x16_bf16 v[64:79], a[32:35], v[160:163], v[64:79]
    buffer_load_dwordx4 a[192:195], v8, s[52:55], s90 offen sc1
    buffer_load_dwordx4 a[196:199], v8, s[56:59], s90 offen sc1
    s_add_u32 s90, s90, 4096
    s_waitcnt vmcnt(24)
    v_mfma_f32_32x32x16_bf16 v[80:95], a[32:35], v[164:167], v[80:95]
    buffer_load_dwordx4 a[200:203], v8, s[52:55], s90 offen sc1
    buffer_load_dwordx4 a[204:207], v8, s[56:59], s90 offen sc1
    s_add_u32 s90, s90, 4096
    v_mfma_f32_32x32x16_bf16 v[96:111], a[36:39], v[160:163], v[96:111]
    v_mfma_f32_32x32x16_bf16 v[112:127], a[36:39], v[164:167], v[112:127]
    s_waitcnt vmcnt(25)
    v_mfma_f32_32x32x16_bf16 v[64:79], a[40:43], v[168:171], v[64:79]
    buffer_load_dwordx4 a[208:211], v8, s[52:55], s90 offen sc1
    buffer_load_dwordx4 a[212:215], v8, s[56:59], s90 offen sc1
    s_add_u32 s90, s90, 4096
    s_waitcnt vmcnt(26)
    v_mfma_f32_32x32x16_bf16 v[80:95], a[40:43], v[172:175], v[80:95]
    buffer_load_dwordx4 a[216:219], v8, s[52:55], s90 offen sc1
    buffer_load_dwordx4 a[220:223], v8, s[56:59], s90 offen sc1
    s_add_u32 s90, s90, 4096
    v_mfma_f32_32x32x16_bf16 v[96:111], a[44:47], v[168:171], v[96:111]
    v_mfma_f32_32x32x16_bf16 v[112:127], a[44:47], v[172:175], v[112:127]
    s_waitcnt vmcnt(27)
    v_mfma_f32_32x32x16_bf16 v[64:79], a[48:51], v[176:179], v[64:79]
    buffer_load_dwordx4 a[224:227], v8, s[52:55], s90 offen sc1
    buffer_load_dwordx4 a[228:231], v8, s[56:59], s90 offen sc1
    s_add_u32 s90, s90, 4096
    s_waitcnt vmcnt(28)
    v_mfma_f32_32x32x16_bf16 v[80:95], a[48:51], v[180:183], v[80:95]
    buffer_load_dwordx4 a[232:235], v8, s[52:55], s90 offen sc1
    buffer_load_dwordx4 a[236:239], v8, s[56:59], s90 offen sc1
    s_add_u32 s90, s90, 4096
    v_mfma_f32_32x32x16_bf16 v[96:111], a[52:55], v[176:179], v[96:111]
    v_mfma_f32_32x32x16_bf16 v[112:127], a[52:55], v[180:183], v[112:127]
    s_waitcnt vmcnt(29)
    v_mfma_f32_32x32x16_bf16 v[64:79], a[56:59], v[184:187], v[64:79]
    s_add_u32 s52, s52, 88064
    s_addc_u32 s53, s53, 0
    s_mov_b32 s54, 65536
    s_add_u32 s56, s56, 88064
    s_addc_u32 s57, s57, 0
    s_mov_b32 s58, 65536
    s_lshr_b32 s90, s5, 1
    s_lshl_b32 s90, s90, 13
    s_and_b32 s92, s5, 1
    s_lshl_b32 s92, s92, 11
    s_add_u32 s90, s90, s92
    buffer_load_dwordx4 a[240:243], v8, s[52:55], s90 offen offset:0 sc1
    buffer_load_dwordx4 a[244:247], v8, s[56:59], s90 offen offset:0 sc1
    s_waitcnt vmcnt(30)
    v_mfma_f32_32x32x16_bf16 v[80:95], a[56:59], v[188:191], v[80:95]
    buffer_load_dwordx4 a[248:251], v8, s[52:55], s90 offen offset:1024 sc1
    buffer_load_dwordx4 a[252:255], v8, s[56:59], s90 offen offset:1024 sc1
    v_mfma_f32_32x32x16_bf16 v[96:111], a[60:63], v[184:187], v[96:111]
    v_mfma_f32_32x32x16_bf16 v[112:127], a[60:63], v[188:191], v[112:127]
    s_waitcnt vmcnt(31)
    v_mfma_f32_32x32x16_bf16 v[64:79], a[64:67], v[192:195], v[64:79]
    s_add_u32 s90, s90, 4096
    buffer_load_dwordx4 v[128:131], v8, s[52:55], s90 offen offset:0 sc1
    buffer_load_dwordx4 v[132:135], v8, s[56:59], s90 offen offset:0 sc1
    s_waitcnt vmcnt(32)
    v_mfma_f32_32x32x16_bf16 v[80:95], a[64:67], v[196:199], v[80:95]
    buffer_load_dwordx4 v[136:139], v8, s[52:55], s90 offen offset:1024 sc1
    buffer_load_dwordx4 v[140:143], v8, s[56:59], s90 offen offset:1024 sc1
    s_add_u32 s90, s90, 12288
    v_mfma_f32_32x32x16_bf16 v[96:111], a[68:71], v[192:195], v[96:111]
    v_mfma_f32_32x32x16_bf16 v[112:127], a[68:71], v[196:199], v[112:127]
    s_waitcnt vmcnt(33)
    v_mfma_f32_32x32x16_bf16 v[64:79], a[72:75], v[200:203], v[64:79]
    buffer_load_dwordx4 v[144:147], v8, s[52:55], s90 offen offset:0 sc1
    buffer_load_dwordx4 v[148:151], v8, s[56:59], s90 offen offset:0 sc1
    s_waitcnt vmcnt(34)
    v_mfma_f32_32x32x16_bf16 v[80:95], a[72:75], v[204:207], v[80:95]
    buffer_load_dwordx4 v[152:155], v8, s[52:55], s90 offen offset:1024 sc1
    buffer_load_dwordx4 v[156:159], v8, s[56:59], s90 offen offset:1024 sc1
    v_mfma_f32_32x32x16_bf16 v[96:111], a[76:79], v[200:203], v[96:111]
    v_mfma_f32_32x32x16_bf16 v[112:127], a[76:79], v[204:207], v[112:127]
    s_waitcnt vmcnt(35)
    v_mfma_f32_32x32x16_bf16 v[64:79], a[80:83], v[208:211], v[64:79]
    s_add_u32 s90, s90, 4096
    buffer_load_dwordx4 v[160:163], v8, s[52:55], s90 offen offset:0 sc1
    buffer_load_dwordx4 v[164:167], v8, s[56:59], s90 offen offset:0 sc1
    s_waitcnt vmcnt(36)
    v_mfma_f32_32x32x16_bf16 v[80:95], a[80:83], v[212:215], v[80:95]
    v_mfma_f32_32x32x16_bf16 v[96:111], a[84:87], v[208:211], v[96:111]
    v_mfma_f32_32x32x16_bf16 v[112:127], a[84:87], v[212:215], v[112:127]
    s_waitcnt vmcnt(35)
    v_mfma_f32_32x32x16_bf16 v[64:79], a[88:91], v[216:219], v[64:79]
    buffer_load_dwordx4 v[168:171], v8, s[52:55], s90 offen offset:1024 sc1
    buffer_load_dwordx4 v[172:175], v8, s[56:59], s90 offen offset:1024 sc1
    s_add_u32 s90, s90, 12288
    s_waitcnt vmcnt(36)
    v_mfma_f32_32x32x16_bf16 v[80:95], a[88:91], v[220:223], v[80:95]
    v_mfma_f32_32x32x16_bf16 v[96:111], a[92:95], v[216:219], v[96:111]
    v_mfma_f32_32x32x16_bf16 v[112:127], a[92:95], v[220:223], v[112:127]
    s_waitcnt vmcnt(35)
    v_mfma_f32_32x32x16_bf16 v[64:79], a[96:99], v[224:227], v[64:79]
    buffer_load_dwordx4 v[176:179], v8, s[52:55], s90 offen offset:0 sc1
    buffer_load_dwordx4 v[180:183], v8, s[56:59], s90 offen offset:0 sc1
    s_waitcnt vmcnt(36)
    v_mfma_f32_32x32x16_bf16 v[80:95], a[96:99], v[228:231], v[80:95]
    v_mfma_f32_32x32x16_bf16 v[96:111], a[100:103], v[224:227], v[96:111]
    v_mfma_f32_32x32x16_bf16 v[112:127], a[100:103], v[228:231], v[112:127]
    s_waitcnt vmcnt(35)
    v_mfma_f32_32x32x16_bf16 v[64:79], a[104:107], v[232:235], v[64:79]
    buffer_load_dwordx4 v[184:187], v8, s[52:55], s90 offen offset:1024 sc1
    buffer_load_dwordx4 v[188:191], v8, s[56:59], s90 offen offset:1024 sc1
    s_waitcnt vmcnt(36)
    v_mfma_f32_32x32x16_bf16 v[80:95], a[104:107], v[236:239], v[80:95]
    v_mfma_f32_32x32x16_bf16 v[96:111], a[108:111], v[232:235], v[96:111]
    v_mfma_f32_32x32x16_bf16 v[112:127], a[108:111], v[236:239], v[112:127]
    s_waitcnt vmcnt(35)
    v_mfma_f32_32x32x16_bf16 v[64:79], a[112:115], a[176:179], v[64:79]
    s_add_u32 s90, s90, 4096
    buffer_load_dwordx4 v[192:195], v8, s[52:55], s90 offen offset:0 sc1
    buffer_load_dwordx4 v[196:199], v8, s[56:59], s90 offen offset:0 sc1
    s_waitcnt vmcnt(36)
    v_mfma_f32_32x32x16_bf16 v[80:95], a[112:115], a[180:183], v[80:95]
    v_mfma_f32_32x32x16_bf16 v[96:111], a[116:119], a[176:179], v[96:111]
    v_mfma_f32_32x32x16_bf16 v[112:127], a[116:119], a[180:183], v[112:127]
    s_waitcnt vmcnt(35)
    v_mfma_f32_32x32x16_bf16 v[64:79], a[120:123], a[184:187], v[64:79]
    buffer_load_dwordx4 v[200:203], v8, s[52:55], s90 offen offset:1024 sc1
    buffer_load_dwordx4 v[204:207], v8, s[56:59], s90 offen offset:1024 sc1
    s_add_u32 s90, s90, 12288
    s_waitcnt vmcnt(36)
    v_mfma_f32_32x32x16_bf16 v[80:95], a[120:123], a[188:191], v[80:95]
    v_mfma_f32_32x32x16_bf16 v[96:111], a[124:127], a[184:187], v[96:111]
    v_mfma_f32_32x32x16_bf16 v[112:127], a[124:127], a[188:191], v[112:127]
    s_waitcnt vmcnt(35)
    v_mfma_f32_32x32x16_bf16 v[64:79], a[128:131], a[192:195], v[64:79]
    buffer_load_dwordx4 v[208:211], v8, s[52:55], s90 offen offset:0 sc1
    buffer_load_dwordx4 v[212:215], v8, s[56:59], s90 offen offset:0 sc1
    s_waitcnt vmcnt(36)
    v_mfma_f32_32x32x16_bf16 v[80:95], a[128:131], a[196:199], v[80:95]
    v_mfma_f32_32x32x16_bf16 v[96:111], a[132:135], a[192:195], v[96:111]
    v_mfma_f32_32x32x16_bf16 v[112:127], a[132:135], a[196:199], v[112:127]
    s_waitcnt vmcnt(35)
    v_mfma_f32_32x32x16_bf16 v[64:79], a[136:139], a[200:203], v[64:79]
    buffer_load_dwordx4 v[216:219], v8, s[52:55], s90 offen offset:1024 sc1
    buffer_load_dwordx4 v[220:223], v8, s[56:59], s90 offen offset:1024 sc1
    s_waitcnt vmcnt(36)
    v_mfma_f32_32x32x16_bf16 v[80:95], a[136:139], a[204:207], v[80:95]
    v_mfma_f32_32x32x16_bf16 v[96:111], a[140:143], a[200:203], v[96:111]
    v_mfma_f32_32x32x16_bf16 v[112:127], a[140:143], a[204:207], v[112:127]
    s_waitcnt vmcnt(35)
    v_mfma_f32_32x32x16_bf16 v[64:79], a[144:147], a[208:211], v[64:79]
    s_add_u32 s90, s90, 4096
    buffer_load_dwordx4 v[224:227], v8, s[52:55], s90 offen offset:0 sc1
    buffer_load_dwordx4 v[228:231], v8, s[56:59], s90 offen offset:0 sc1
    s_waitcnt vmcnt(36)
    v_mfma_f32_32x32x16_bf16 v[80:95], a[144:147], a[212:215], v[80:95]
    v_mfma_f32_32x32x16_bf16 v[96:111], a[148:151], a[208:211], v[96:111]
    v_mfma_f32_32x32x16_bf16 v[112:127], a[148:151], a[212:215], v[112:127]
    s_waitcnt vmcnt(35)
    v_mfma_f32_32x32x16_bf16 v[64:79], a[152:155], a[216:219], v[64:79]
    buffer_load_dwordx4 v[232:235], v8, s[52:55], s90 offen offset:1024 sc1
    buffer_load_dwordx4 v[236:239], v8, s[56:59], s90 offen offset:1024 sc1
    s_add_u32 s90, s90, 12288
    s_waitcnt vmcnt(36)
    v_mfma_f32_32x32x16_bf16 v[80:95], a[152:155], a[220:223], v[80:95]
    v_mfma_f32_32x32x16_bf16 v[96:111], a[156:159], a[216:219], v[96:111]
    v_mfma_f32_32x32x16_bf16 v[112:127], a[156:159], a[220:223], v[112:127]
    s_waitcnt vmcnt(35)
    v_mfma_f32_32x32x16_bf16 v[64:79], a[160:163], a[224:227], v[64:79]
    s_waitcnt vmcnt(34)
    v_mfma_f32_32x32x16_bf16 v[80:95], a[160:163], a[228:231], v[80:95]
    v_mfma_f32_32x32x16_bf16 v[96:111], a[164:167], a[224:227], v[96:111]
    v_mfma_f32_32x32x16_bf16 v[112:127], a[164:167], a[228:231], v[112:127]
    s_waitcnt vmcnt(33)
    v_mfma_f32_32x32x16_bf16 v[64:79], a[168:171], a[232:235], v[64:79]
    ds_read_b128 v[240:243], v15 offset:16384
    ds_read_b128 v[244:247], v15 offset:20480
    s_waitcnt vmcnt(32)
    v_mfma_f32_32x32x16_bf16 v[80:95], a[168:171], a[236:239], v[80:95]
    v_mfma_f32_32x32x16_bf16 v[96:111], a[172:175], a[232:235], v[96:111]
    v_mfma_f32_32x32x16_bf16 v[112:127], a[172:175], a[236:239], v[112:127]
    s_waitcnt vmcnt(31) lgkmcnt(1)
    v_mfma_f32_32x32x16_bf16 v[64:79], v[240:243], a[240:243], v[64:79]
    ds_read_b128 v[248:251], v16 offset:16384
    ds_read_b128 v[252:255], v16 offset:20480
    s_waitcnt vmcnt(30)
    v_mfma_f32_32x32x16_bf16 v[80:95], v[240:243], a[244:247], v[80:95]
    s_waitcnt lgkmcnt(2)
    v_mfma_f32_32x32x16_bf16 v[96:111], v[244:247], a[240:243], v[96:111]
    v_mfma_f32_32x32x16_bf16 v[112:127], v[244:247], a[244:247], v[112:127]
    s_waitcnt vmcnt(29) lgkmcnt(1)
    v_mfma_f32_32x32x16_bf16 v[64:79], v[248:251], a[248:251], v[64:79]
    ds_read_b128 v[240:243], v24 offset:16384
    ds_read_b128 v[244:247], v24 offset:20480
    s_waitcnt vmcnt(28)
    v_mfma_f32_32x32x16_bf16 v[80:95], v[248:251], a[252:255], v[80:95]
    s_waitcnt lgkmcnt(2)
    v_mfma_f32_32x32x16_bf16 v[96:111], v[252:255], a[248:251], v[96:111]
    v_mfma_f32_32x32x16_bf16 v[112:127], v[252:255], a[252:255], v[112:127]
    s_waitcnt vmcnt(27) lgkmcnt(1)
    v_mfma_f32_32x32x16_bf16 v[64:79], v[240:243], v[128:131], v[64:79]
    ds_read_b128 v[248:251], v25 offset:16384
    ds_read_b128 v[252:255], v25 offset:20480
    s_waitcnt vmcnt(26)
    v_mfma_f32_32x32x16_bf16 v[80:95], v[240:243], v[132:135], v[80:95]
    s_waitcnt lgkmcnt(2)
    v_mfma_f32_32x32x16_bf16 v[96:111], v[244:247], v[128:131], v[96:111]
    v_mfma_f32_32x32x16_bf16 v[112:127], v[244:247], v[132:135], v[112:127]
    s_waitcnt vmcnt(25) lgkmcnt(1)
    v_mfma_f32_32x32x16_bf16 v[64:79], v[248:251], v[136:139], v[64:79]
    ds_read_b128 v[240:243], v15 offset:24576
    ds_read_b128 v[244:247], v15 offset:28672
    s_waitcnt vmcnt(24)
    v_mfma_f32_32x32x16_bf16 v[80:95], v[248:251], v[140:143], v[80:95]
    s_waitcnt lgkmcnt(2)
    v_mfma_f32_32x32x16_bf16 v[96:111], v[252:255], v[136:139], v[96:111]
    v_mfma_f32_32x32x16_bf16 v[112:127], v[252:255], v[140:143], v[112:127]
    s_waitcnt vmcnt(23) lgkmcnt(1)
    v_mfma_f32_32x32x16_bf16 v[64:79], v[240:243], v[144:147], v[64:79]
    ds_read_b128 v[248:251], v16 offset:24576
    ds_read_b128 v[252:255], v16 offset:28672
    s_waitcnt vmcnt(22)
    v_mfma_f32_32x32x16_bf16 v[80:95], v[240:243], v[148:151], v[80:95]
    s_waitcnt lgkmcnt(2)
    v_mfma_f32_32x32x16_bf16 v[96:111], v[244:247], v[144:147], v[96:111]
    v_mfma_f32_32x32x16_bf16 v[112:127], v[244:247], v[148:151], v[112:127]
    s_waitcnt vmcnt(21) lgkmcnt(1)
    v_mfma_f32_32x32x16_bf16 v[64:79], v[248:251], v[152:155], v[64:79]
    ds_read_b128 v[240:243], v24 offset:24576
    ds_read_b128 v[244:247], v24 offset:28672
    s_waitcnt vmcnt(20)
    v_mfma_f32_32x32x16_bf16 v[80:95], v[248:251], v[156:159], v[80:95]
    s_waitcnt lgkmcnt(2)
    v_mfma_f32_32x32x16_bf16 v[96:111], v[252:255], v[152:155], v[96:111]
    v_mfma_f32_32x32x16_bf16 v[112:127], v[252:255], v[156:159], v[112:127]
    s_waitcnt vmcnt(19) lgkmcnt(1)
    v_mfma_f32_32x32x16_bf16 v[64:79], v[240:243], v[160:163], v[64:79]
    ds_read_b128 v[248:251], v25 offset:24576
    ds_read_b128 v[252:255], v25 offset:28672
    s_waitcnt vmcnt(18)
    v_mfma_f32_32x32x16_bf16 v[80:95], v[240:243], v[164:167], v[80:95]
    s_waitcnt lgkmcnt(2)
    v_mfma_f32_32x32x16_bf16 v[96:111], v[244:247], v[160:163], v[96:111]
    v_mfma_f32_32x32x16_bf16 v[112:127], v[244:247], v[164:167], v[112:127]
    s_waitcnt vmcnt(17) lgkmcnt(1)
    v_mfma_f32_32x32x16_bf16 v[64:79], v[248:251], v[168:171], v[64:79]
    ds_read_b128 v[240:243], v15 offset:0
    ds_read_b128 v[244:247], v15 offset:4096
    s_waitcnt vmcnt(16)
    v_mfma_f32_32x32x16_bf16 v[80:95], v[248:251], v[172:175], v[80:95]
    s_waitcnt lgkmcnt(2)
    v_mfma_f32_32x32x16_bf16 v[96:111], v[252:255], v[168:171], v[96:111]
    v_mfma_f32_32x32x16_bf16 v[112:127], v[252:255], v[172:175], v[112:127]
    s_waitcnt vmcnt(15) lgkmcnt(1)
    v_mfma_f32_32x32x16_bf16 v[64:79], v[240:243], v[176:179], v[64:79]
    ds_read_b128 v[248:251], v16 offset:0
    ds_read_b128 v[252:255], v16 offset:4096
    s_waitcnt vmcnt(14)
    v_mfma_f32_32x32x16_bf16 v[80:95], v[240:243], v[180:183], v[80:95]
    s_waitcnt lgkmcnt(2)
    v_mfma_f32_32x32x16_bf16 v[96:111], v[244:247], v[176:179], v[96:111]
    v_mfma_f32_32x32x16_bf16 v[112:127], v[244:247], v[180:183], v[112:127]
    s_waitcnt vmcnt(13) lgkmcnt(1)
    v_mfma_f32_32x32x16_bf16 v[64:79], v[248:251], v[184:187], v[64:79]
    ds_read_b128 v[240:243], v24 offset:0
    ds_read_b128 v[244:247], v24 offset:4096
    s_waitcnt vmcnt(12)
    v_mfma_f32_32x32x16_bf16 v[80:95], v[248:251], v[188:191], v[80:95]
    s_waitcnt lgkmcnt(2)
    v_mfma_f32_32x32x16_bf16 v[96:111], v[252:255], v[184:187], v[96:111]
    v_mfma_f32_32x32x16_bf16 v[112:127], v[252:255], v[188:191], v[112:127]
    s_waitcnt vmcnt(11) lgkmcnt(1)
    v_mfma_f32_32x32x16_bf16 v[64:79], v[240:243], v[192:195], v[64:79]
    ds_read_b128 v[248:251], v25 offset:0
    ds_read_b128 v[252:255], v25 offset:4096
    s_waitcnt vmcnt(10)
    v_mfma_f32_32x32x16_bf16 v[80:95], v[240:243], v[196:199], v[80:95]
    s_waitcnt lgkmcnt(2)
    v_mfma_f32_32x32x16_bf16 v[96:111], v[244:247], v[192:195], v[96:111]
    v_mfma_f32_32x32x16_bf16 v[112:127], v[244:247], v[196:199], v[112:127]
    s_waitcnt vmcnt(9) lgkmcnt(1)
    v_mfma_f32_32x32x16_bf16 v[64:79], v[248:251], v[200:203], v[64:79]
    ds_read_b128 v[240:243], v15 offset:8192
    ds_read_b128 v[244:247], v15 offset:12288
    s_waitcnt vmcnt(8)
    v_mfma_f32_32x32x16_bf16 v[80:95], v[248:251], v[204:207], v[80:95]
    s_waitcnt lgkmcnt(2)
    v_mfma_f32_32x32x16_bf16 v[96:111], v[252:255], v[200:203], v[96:111]
    v_mfma_f32_32x32x16_bf16 v[112:127], v[252:255], v[204:207], v[112:127]
    s_waitcnt vmcnt(7) lgkmcnt(1)
    v_mfma_f32_32x32x16_bf16 v[64:79], v[240:243], v[208:211], v[64:79]
    ds_read_b128 v[248:251], v16 offset:8192
    ds_read_b128 v[252:255], v16 offset:12288
    s_waitcnt vmcnt(6)
    v_mfma_f32_32x32x16_bf16 v[80:95], v[240:243], v[212:215], v[80:95]
    s_waitcnt lgkmcnt(2)
    v_mfma_f32_32x32x16_bf16 v[96:111], v[244:247], v[208:211], v[96:111]
    v_mfma_f32_32x32x16_bf16 v[112:127], v[244:247], v[212:215], v[112:127]
    s_waitcnt vmcnt(5) lgkmcnt(1)
    v_mfma_f32_32x32x16_bf16 v[64:79], v[248:251], v[216:219], v[64:79]
    ds_read_b128 v[240:243], v24 offset:8192
    ds_read_b128 v[244:247], v24 offset:12288
    s_waitcnt vmcnt(4)
    v_mfma_f32_32x32x16_bf16 v[80:95], v[248:251], v[220:223], v[80:95]
    s_waitcnt lgkmcnt(2)
    v_mfma_f32_32x32x16_bf16 v[96:111], v[252:255], v[216:219], v[96:111]
    v_mfma_f32_32x32x16_bf16 v[112:127], v[252:255], v[220:223], v[112:127]
    s_waitcnt vmcnt(3) lgkmcnt(1)
    v_mfma_f32_32x32x16_bf16 v[64:79], v[240:243], v[224:227], v[64:79]
    ds_read_b128 v[248:251], v25 offset:8192
    ds_read_b128 v[252:255], v25 offset:12288
    s_waitcnt vmcnt(2)
    v_mfma_f32_32x32x16_bf16 v[80:95], v[240:243], v[228:231], v[80:95]
    s_waitcnt lgkmcnt(2)
    v_mfma_f32_32x32x16_bf16 v[96:111], v[244:247], v[224:227], v[96:111]
    v_mfma_f32_32x32x16_bf16 v[112:127], v[244:247], v[228:231], v[112:127]
    s_waitcnt vmcnt(1) lgkmcnt(1)
    v_mfma_f32_32x32x16_bf16 v[64:79], v[248:251], v[232:235], v[64:79]
    s_waitcnt vmcnt(0)
    v_mfma_f32_32x32x16_bf16 v[80:95], v[248:251], v[236:239], v[80:95]
    s_waitcnt lgkmcnt(0)
    v_mfma_f32_32x32x16_bf16 v[96:111], v[252:255], v[232:235], v[96:111]
    v_mfma_f32_32x32x16_bf16 v[112:127], v[252:255], v[236:239], v[112:127]
    v_and_b32 v46, 31, v1
    v_lshrrev_b32 v47, 5, v1
    v_and_b32 v48, 15, v1
    v_xor_b32 v48, v48, v47
    v_lshlrev_b32 v48, 4, v48
    v_lshlrev_b32 v49, 8, v46
    v_add_u32 v49, s78, v49
    v_xor_b32 v50, 0, v48
    v_add_u32 v52, v49, v50
    v_xor_b32 v50, 32, v48
    v_add_u32 v53, v49, v50
    v_xor_b32 v50, 64, v48
    v_add_u32 v54, v49, v50
    v_xor_b32 v50, 96, v48
    v_add_u32 v55, v49, v50
    v_xor_b32 v50, 128, v48
    v_add_u32 v56, v49, v50
    v_xor_b32 v50, 160, v48
    v_add_u32 v57, v49, v50
    v_xor_b32 v50, 192, v48
    v_add_u32 v58, v49, v50
    v_xor_b32 v50, 224, v48
    v_add_u32 v59, v49, v50
    ds_write_b128 v52, v[64:67] offset:0
    ds_write_b128 v53, v[68:71] offset:0
    ds_write_b128 v54, v[72:75] offset:0
    ds_write_b128 v55, v[76:79] offset:0
    ds_write_b128 v52, v[80:83] offset:8192
    ds_write_b128 v53, v[84:87] offset:8192
    ds_write_b128 v54, v[88:91] offset:8192
    ds_write_b128 v55, v[92:95] offset:8192
    ds_write_b128 v56, v[96:99] offset:0
    ds_write_b128 v57, v[100:103] offset:0
    ds_write_b128 v58, v[104:107] offset:0
    ds_write_b128 v59, v[108:111] offset:0
    ds_write_b128 v56, v[112:115] offset:8192
    ds_write_b128 v57, v[116:119] offset:8192
    ds_write_b128 v58, v[120:123] offset:8192
    ds_write_b128 v59, v[124:127] offset:8192
    s_mov_b32 s88, 0xffff0000
    v_lshlrev_b32 v2, 16, v44
    v_and_b32 v3, s88, v44
    v_lshlrev_b32 v4, 16, v45
    v_and_b32 v5, s88, v45
    v_lshlrev_b32 v192, 16, v28
    v_lshlrev_b32 v204, 16, v30
    v_lshlrev_b32 v216, 16, v32
    v_lshlrev_b32 v228, 16, v34
    v_and_b32 v193, s88, v28
    v_and_b32 v205, s88, v30
    v_and_b32 v217, s88, v32
    v_and_b32 v229, s88, v34
    v_lshlrev_b32 v194, 16, v29
    v_lshlrev_b32 v206, 16, v31
    v_lshlrev_b32 v218, 16, v33
    v_lshlrev_b32 v230, 16, v35
    v_and_b32 v195, s88, v29
    v_and_b32 v207, s88, v31
    v_and_b32 v219, s88, v33
    v_and_b32 v231, s88, v35
    v_sub_f32 v196, v192, v36
    v_sub_f32 v208, v204, v38
    v_sub_f32 v220, v216, v40
    v_sub_f32 v232, v228, v42
    v_sub_f32 v197, v193, v36
    v_sub_f32 v209, v205, v38
    v_sub_f32 v221, v217, v40
    v_sub_f32 v233, v229, v42
    v_sub_f32 v198, v194, v36
    v_sub_f32 v210, v206, v38
    v_sub_f32 v222, v218, v40
    v_sub_f32 v234, v230, v42
    v_sub_f32 v199, v195, v36
    v_sub_f32 v211, v207, v38
    v_sub_f32 v223, v219, v40
    v_sub_f32 v235, v231, v42
    v_cvt_pk_bf16_f32 v200, v196, v197
    v_cvt_pk_bf16_f32 v212, v208, v209
    v_cvt_pk_bf16_f32 v224, v220, v221
    v_cvt_pk_bf16_f32 v236, v232, v233
    v_lshlrev_b32 v196, 16, v200
    v_lshlrev_b32 v208, 16, v212
    v_lshlrev_b32 v220, 16, v224
    v_lshlrev_b32 v232, 16, v236
    v_and_b32 v197, s88, v200
    v_and_b32 v209, s88, v212
    v_and_b32 v221, s88, v224
    v_and_b32 v233, s88, v236
    v_cvt_pk_bf16_f32 v201, v198, v199
    v_cvt_pk_bf16_f32 v213, v210, v211
    v_cvt_pk_bf16_f32 v225, v222, v223
    v_cvt_pk_bf16_f32 v237, v234, v235
    v_lshlrev_b32 v198, 16, v201
    v_lshlrev_b32 v210, 16, v213
    v_lshlrev_b32 v222, 16, v225
    v_lshlrev_b32 v234, 16, v237
    v_and_b32 v199, s88, v201
    v_and_b32 v211, s88, v213
    v_and_b32 v223, s88, v225
    v_and_b32 v235, s88, v237
    v_mul_f32 v196, v196, v37
    v_mul_f32 v208, v208, v39
    v_mul_f32 v220, v220, v41
    v_mul_f32 v232, v232, v43
    v_mul_f32 v197, v197, v37
    v_mul_f32 v209, v209, v39
    v_mul_f32 v221, v221, v41
    v_mul_f32 v233, v233, v43
    v_mul_f32 v198, v198, v37
    v_mul_f32 v210, v210, v39
    v_mul_f32 v222, v222, v41
    v_mul_f32 v234, v234, v43
    v_mul_f32 v199, v199, v37
    v_mul_f32 v211, v211, v39
    v_mul_f32 v223, v223, v41
    v_mul_f32 v235, v235, v43
    v_cvt_pk_bf16_f32 v200, v196, v197
    v_cvt_pk_bf16_f32 v212, v208, v209
    v_cvt_pk_bf16_f32 v224, v220, v221
    v_cvt_pk_bf16_f32 v236, v232, v233
    v_lshlrev_b32 v196, 16, v200
    v_lshlrev_b32 v208, 16, v212
    v_lshlrev_b32 v220, 16, v224
    v_lshlrev_b32 v232, 16, v236
    v_and_b32 v197, s88, v200
    v_and_b32 v209, s88, v212
    v_and_b32 v221, s88, v224
    v_and_b32 v233, s88, v236
    v_cvt_pk_bf16_f32 v201, v198, v199
    v_cvt_pk_bf16_f32 v213, v210, v211
    v_cvt_pk_bf16_f32 v225, v222, v223
    v_cvt_pk_bf16_f32 v237, v234, v235
    v_lshlrev_b32 v198, 16, v201
    v_lshlrev_b32 v210, 16, v213
    v_lshlrev_b32 v222, 16, v225
    v_lshlrev_b32 v234, 16, v237
    v_and_b32 v199, s88, v201
    v_and_b32 v211, s88, v213
    v_and_b32 v223, s88, v225
    v_and_b32 v235, s88, v237
    v_mul_f32 v196, v196, v2
    v_mul_f32 v208, v208, v2
    v_mul_f32 v220, v220, v2
    v_mul_f32 v232, v232, v2
    v_mul_f32 v197, v197, v3
    v_mul_f32 v209, v209, v3
    v_mul_f32 v221, v221, v3
    v_mul_f32 v233, v233, v3
    v_mul_f32 v198, v198, v4
    v_mul_f32 v210, v210, v4
    v_mul_f32 v222, v222, v4
    v_mul_f32 v234, v234, v4
    v_mul_f32 v199, v199, v5
    v_mul_f32 v211, v211, v5
    v_mul_f32 v223, v223, v5
    v_mul_f32 v235, v235, v5
    v_cvt_pk_bf16_f32 v200, v196, v197
    v_cvt_pk_bf16_f32 v212, v208, v209
    v_cvt_pk_bf16_f32 v224, v220, v221
    v_cvt_pk_bf16_f32 v236, v232, v233
    v_lshlrev_b32 v196, 16, v200
    v_lshlrev_b32 v208, 16, v212
    v_lshlrev_b32 v220, 16, v224
    v_lshlrev_b32 v232, 16, v236
    v_and_b32 v197, s88, v200
    v_and_b32 v209, s88, v212
    v_and_b32 v221, s88, v224
    v_and_b32 v233, s88, v236
    v_cvt_pk_bf16_f32 v201, v198, v199
    v_cvt_pk_bf16_f32 v213, v210, v211
    v_cvt_pk_bf16_f32 v225, v222, v223
    v_cvt_pk_bf16_f32 v237, v234, v235
    v_lshlrev_b32 v198, 16, v201
    v_lshlrev_b32 v210, 16, v213
    v_lshlrev_b32 v222, 16, v225
    v_lshlrev_b32 v234, 16, v237
    v_and_b32 v199, s88, v201
    v_and_b32 v211, s88, v213
    v_and_b32 v223, s88, v225
    v_and_b32 v235, s88, v237
    v_pk_add_f32 v[192:193], v[192:193], v[196:197]
    v_pk_add_f32 v[204:205], v[204:205], v[208:209]
    v_pk_add_f32 v[216:217], v[216:217], v[220:221]
    v_pk_add_f32 v[228:229], v[228:229], v[232:233]
    v_pk_add_f32 v[194:195], v[194:195], v[198:199]
    v_pk_add_f32 v[206:207], v[206:207], v[210:211]
    v_pk_add_f32 v[218:219], v[218:219], v[222:223]
    v_pk_add_f32 v[230:231], v[230:231], v[234:235]
    s_waitcnt lgkmcnt(0)
    s_barrier
    v_add_u32 v46, 0, v11
    v_and_b32 v47, 15, v46
    v_xor_b32 v47, v47, v12
    v_lshlrev_b32 v47, 4, v47
    v_lshl_add_u32 v56, v46, 8, v47
    v_add_u32 v60, 65536, v56
    v_add_u32 v46, 4, v11
    v_and_b32 v47, 15, v46
    v_xor_b32 v47, v47, v12
    v_lshlrev_b32 v47, 4, v47
    v_lshl_add_u32 v57, v46, 8, v47
    v_add_u32 v61, 65536, v57
    v_add_u32 v46, 8, v11
    v_and_b32 v47, 15, v46
    v_xor_b32 v47, v47, v12
    v_lshlrev_b32 v47, 4, v47
    v_lshl_add_u32 v58, v46, 8, v47
    v_add_u32 v62, 65536, v58
    v_add_u32 v46, 12, v11
    v_and_b32 v47, 15, v46
    v_xor_b32 v47, v47, v12
    v_lshlrev_b32 v47, 4, v47
    v_lshl_add_u32 v59, v46, 8, v47
    v_add_u32 v63, 65536, v59
    ds_read_b128 v[128:131], v56 offset:0
    ds_read_b128 v[132:135], v56 offset:32768
    ds_read_b128 v[136:139], v60 offset:0
    ds_read_b128 v[140:143], v60 offset:32768
    ds_read_b128 v[144:147], v57 offset:0
    ds_read_b128 v[148:151], v57 offset:32768
    ds_read_b128 v[152:155], v61 offset:0
    ds_read_b128 v[156:159], v61 offset:32768
    ds_read_b128 v[160:163], v58 offset:0
    ds_read_b128 v[164:167], v58 offset:32768
    ds_read_b128 v[168:171], v62 offset:0
    ds_read_b128 v[172:175], v62 offset:32768
    ds_read_b128 v[176:179], v59 offset:0
    ds_read_b128 v[180:183], v59 offset:32768
    ds_read_b128 v[184:187], v63 offset:0
    ds_read_b128 v[188:191], v63 offset:32768
    s_lshl_b32 s92, s89, 8
    v_lshlrev_b32 v50, 11, v13
    v_lshl_add_u32 v50, v12, 4, v50
    v_add_u32 v50, s92, v50
    s_mov_b32 s84, 0
    s_movk_i32 s85, 8192
    s_movk_i32 s86, 16384
    s_movk_i32 s87, 24576
    s_waitcnt lgkmcnt(14)
    v_pk_add_f32 v[128:129], v[128:129], v[132:133]
    s_waitcnt lgkmcnt(12)
    v_pk_add_f32 v[136:137], v[136:137], v[140:141]
    v_pk_add_f32 v[130:131], v[130:131], v[134:135]
    v_pk_add_f32 v[138:139], v[138:139], v[142:143]
    v_pk_add_f32 v[128:129], v[128:129], v[136:137]
    v_pk_add_f32 v[128:129], v[128:129], v[192:193]
    v_pk_add_f32 v[130:131], v[130:131], v[138:139]
    v_pk_add_f32 v[130:131], v[130:131], v[194:195]
    buffer_store_dwordx4 v[128:131], v50, s[72:75], s84 offen
    s_waitcnt lgkmcnt(10)
    v_pk_add_f32 v[144:145], v[144:145], v[148:149]
    s_waitcnt lgkmcnt(8)
    v_pk_add_f32 v[152:153], v[152:153], v[156:157]
    v_pk_add_f32 v[146:147], v[146:147], v[150:151]
    v_pk_add_f32 v[154:155], v[154:155], v[158:159]
    v_pk_add_f32 v[144:145], v[144:145], v[152:153]
    v_pk_add_f32 v[144:145], v[144:145], v[204:205]
    v_pk_add_f32 v[146:147], v[146:147], v[154:155]
    v_pk_add_f32 v[146:147], v[146:147], v[206:207]
    buffer_store_dwordx4 v[144:147], v50, s[72:75], s85 offen
    s_waitcnt lgkmcnt(6)
    v_pk_add_f32 v[160:161], v[160:161], v[164:165]
    s_waitcnt lgkmcnt(4)
    v_pk_add_f32 v[168:169], v[168:169], v[172:173]
    v_pk_add_f32 v[162:163], v[162:163], v[166:167]
    v_pk_add_f32 v[170:171], v[170:171], v[174:175]
    v_pk_add_f32 v[160:161], v[160:161], v[168:169]
    v_pk_add_f32 v[160:161], v[160:161], v[216:217]
    v_pk_add_f32 v[162:163], v[162:163], v[170:171]
    v_pk_add_f32 v[162:163], v[162:163], v[218:219]
    buffer_store_dwordx4 v[160:163], v50, s[72:75], s86 offen
    s_waitcnt lgkmcnt(2)
    v_pk_add_f32 v[176:177], v[176:177], v[180:181]
    s_waitcnt lgkmcnt(0)
    v_pk_add_f32 v[184:185], v[184:185], v[188:189]
    v_pk_add_f32 v[178:179], v[178:179], v[182:183]
    v_pk_add_f32 v[186:187], v[186:187], v[190:191]
    v_pk_add_f32 v[176:177], v[176:177], v[184:185]
    v_pk_add_f32 v[176:177], v[176:177], v[228:229]
    v_pk_add_f32 v[178:179], v[178:179], v[186:187]
    v_pk_add_f32 v[178:179], v[178:179], v[230:231]
    buffer_store_dwordx4 v[176:179], v50, s[72:75], s87 offen
L_p1_end:
s_endpgm
L_p1_nslow:
s_mov_b32 s94, 400000
L_p1_nspin:
s_sleep 1
buffer_load_dword v91, off, s[64:67], 0 sc1
s_waitcnt vmcnt(0)
v_readfirstlane_b32 s92, v91
s_sub_u32 s94, s94, 1
s_cmp_eq_u32 s94, 0
s_cbranch_scc1 L_p1_nok
s_cmp_eq_u32 s92, 0
s_cbranch_scc1 L_p1_nspin
s_branch L_p1_nok
L_p1_ln0_slow:
s_mov_b32 s94, 400000
L_p1_ln0_spin:
s_sleep 1
buffer_load_dwordx4 v[208:211], v64, s[60:63], s68 offen sc1
buffer_load_dwordx4 v[212:215], v64, s[60:63], s68 offen offset:512 sc1
buffer_load_dwordx4 v[192:195], v65, s[60:63], s69 offen offset:0 sc1
buffer_load_dwordx4 v[196:199], v65, s[60:63], s69 offen offset:512 sc1
buffer_load_dwordx4 v[200:203], v65, s[60:63], s69 offen offset:2048 sc1
buffer_load_dwordx4 v[204:207], v65, s[60:63], s69 offen offset:2560 sc1
s_waitcnt vmcnt(0)
v_mov_b32 v66, 0
v_bitop3_b32 v66, v66, v193, s85 bitop3:0xf6
v_bitop3_b32 v66, v66, v195, s85 bitop3:0xf6
v_bitop3_b32 v66, v66, v197, s85 bitop3:0xf6
v_bitop3_b32 v66, v66, v199, s85 bitop3:0xf6
v_bitop3_b32 v66, v66, v201, s85 bitop3:0xf6
v_bitop3_b32 v66, v66, v203, s85 bitop3:0xf6
v_bitop3_b32 v66, v66, v205, s85 bitop3:0xf6
v_bitop3_b32 v66, v66, v207, s85 bitop3:0xf6
v_bitop3_b32 v66, v66, v209, s85 bitop3:0xf6
v_bitop3_b32 v66, v66, v211, s85 bitop3:0xf6
v_bitop3_b32 v66, v66, v213, s85 bitop3:0xf6
v_bitop3_b32 v66, v66, v215, s85 bitop3:0xf6
v_cmp_ne_u32 vcc, 0, v66
s_nop 4
s_sub_u32 s94, s94, 1
s_cmp_eq_u32 s94, 0
s_cbranch_scc1 L_p1_ln0_ok
s_cbranch_vccnz L_p1_ln0_spin
s_branch L_p1_ln0_ok
L_p1_agslow:
s_mov_b32 s94, 400000
L_p1_agspin:
s_sleep 1
s_add_u32 s93, s92, 0
s_cmp_ge_u32 s3, 15
s_cselect_b32 s93, s93, s84
buffer_load_dwordx4 v[96:99], v7, s[60:63], s93 offen sc1
s_add_u32 s93, s92, 512
s_cmp_ge_u32 s3, 14
s_cselect_b32 s93, s93, s84
buffer_load_dwordx4 v[100:103], v7, s[60:63], s93 offen sc1
s_add_u32 s93, s92, 1024
s_cmp_ge_u32 s3, 13
s_cselect_b32 s93, s93, s84
buffer_load_dwordx4 v[104:107], v7, s[60:63], s93 offen sc1
s_add_u32 s93, s92, 1536
s_cmp_ge_u32 s3, 12
s_cselect_b32 s93, s93, s84
buffer_load_dwordx4 v[108:111], v7, s[60:63], s93 offen sc1
s_add_u32 s93, s92, 2048
s_cmp_ge_u32 s3, 11
s_cselect_b32 s93, s93, s84
buffer_load_dwordx4 v[112:115], v7, s[60:63], s93 offen sc1
s_add_u32 s93, s92, 2560
s_cmp_ge_u32 s3, 10
s_cselect_b32 s93, s93, s84
buffer_load_dwordx4 v[116:119], v7, s[60:63], s93 offen sc1
s_add_u32 s93, s92, 3072
s_cmp_ge_u32 s3, 9
s_cselect_b32 s93, s93, s84
buffer_load_dwordx4 v[120:123], v7, s[60:63], s93 offen sc1
s_add_u32 s93, s92, 3584
s_cmp_ge_u32 s3, 8
s_cselect_b32 s93, s93, s84
buffer_load_dwordx4 v[124:127], v7, s[60:63], s93 offen sc1
s_add_u32 s93, s92, 4096
s_cmp_ge_u32 s3, 7
s_cselect_b32 s93, s93, s84
buffer_load_dwordx4 v[160:163], v7, s[60:63], s93 offen sc1
s_add_u32 s93, s92, 4608
s_cmp_ge_u32 s3, 6
s_cselect_b32 s93, s93, s84
buffer_load_dwordx4 v[164:167], v7, s[60:63], s93 offen sc1
s_add_u32 s93, s92, 5120
s_cmp_ge_u32 s3, 5
s_cselect_b32 s93, s93, s84
buffer_load_dwordx4 v[168:171], v7, s[60:63], s93 offen sc1
s_add_u32 s93, s92, 5632
s_cmp_ge_u32 s3, 4
s_cselect_b32 s93, s93, s84
buffer_load_dwordx4 v[172:175], v7, s[60:63], s93 offen sc1
s_add_u32 s93, s92, 6144
s_cmp_ge_u32 s3, 3
s_cselect_b32 s93, s93, s84
buffer_load_dwordx4 v[176:179], v7, s[60:63], s93 offen sc1
s_add_u32 s93, s92, 6656
s_cmp_ge_u32 s3, 2
s_cselect_b32 s93, s93, s84
buffer_load_dwordx4 v[180:183], v7, s[60:63], s93 offen sc1
s_add_u32 s93, s92, 7168
s_cmp_ge_u32 s3, 1
s_cselect_b32 s93, s93, s84
buffer_load_dwordx4 v[20:23], v7, s[60:63], s93 offen sc1
s_waitcnt vmcnt(0)
v_mov_b32 v8, 0
v_bitop3_b32 v8, v8, v97, s85 bitop3:0xf6
v_bitop3_b32 v8, v8, v99, s85 bitop3:0xf6
v_bitop3_b32 v8, v8, v101, s85 bitop3:0xf6
v_bitop3_b32 v8, v8, v103, s85 bitop3:0xf6
v_bitop3_b32 v8, v8, v105, s85 bitop3:0xf6
v_bitop3_b32 v8, v8, v107, s85 bitop3:0xf6
v_bitop3_b32 v8, v8, v109, s85 bitop3:0xf6
v_bitop3_b32 v8, v8, v111, s85 bitop3:0xf6
v_bitop3_b32 v8, v8, v113, s85 bitop3:0xf6
v_bitop3_b32 v8, v8, v115, s85 bitop3:0xf6
v_bitop3_b32 v8, v8, v117, s85 bitop3:0xf6
v_bitop3_b32 v8, v8, v119, s85 bitop3:0xf6
v_bitop3_b32 v8, v8, v121, s85 bitop3:0xf6
v_bitop3_b32 v8, v8, v123, s85 bitop3:0xf6
v_bitop3_b32 v8, v8, v125, s85 bitop3:0xf6
v_bitop3_b32 v8, v8, v127, s85 bitop3:0xf6
v_bitop3_b32 v8, v8, v161, s85 bitop3:0xf6
v_bitop3_b32 v8, v8, v163, s85 bitop3:0xf6
v_bitop3_b32 v8, v8, v165, s85 bitop3:0xf6
v_bitop3_b32 v8, v8, v167, s85 bitop3:0xf6
v_bitop3_b32 v8, v8, v169, s85 bitop3:0xf6
v_bitop3_b32 v8, v8, v171, s85 bitop3:0xf6
v_bitop3_b32 v8, v8, v173, s85 bitop3:0xf6
v_bitop3_b32 v8, v8, v175, s85 bitop3:0xf6
v_bitop3_b32 v8, v8, v177, s85 bitop3:0xf6
v_bitop3_b32 v8, v8, v179, s85 bitop3:0xf6
v_bitop3_b32 v8, v8, v181, s85 bitop3:0xf6
v_bitop3_b32 v8, v8, v183, s85 bitop3:0xf6
v_bitop3_b32 v8, v8, v21, s85 bitop3:0xf6
v_bitop3_b32 v8, v8, v23, s85 bitop3:0xf6
v_cmp_ne_u32 vcc, 0, v8
s_nop 4
s_sub_u32 s94, s94, 1
s_cmp_eq_u32 s94, 0
s_cbranch_scc1 L_p1_agok
s_cbranch_vccnz L_p1_agspin
s_branch L_p1_agok
L_p1_ln1_slow:
s_mov_b32 s94, 400000
L_p1_ln1_spin:
s_sleep 1
buffer_load_dwordx4 v[208:211], v64, s[60:63], s68 offen sc1
buffer_load_dwordx4 v[212:215], v64, s[60:63], s68 offen offset:512 sc1
buffer_load_dwordx4 v[192:195], v65, s[60:63], s69 offen offset:0 sc1
buffer_load_dwordx4 v[196:199], v65, s[60:63], s69 offen offset:512 sc1
buffer_load_dwordx4 v[200:203], v65, s[60:63], s69 offen offset:2048 sc1
buffer_load_dwordx4 v[204:207], v65, s[60:63], s69 offen offset:2560 sc1
s_waitcnt vmcnt(0)
v_mov_b32 v66, 0
v_bitop3_b32 v66, v66, v193, s85 bitop3:0xf6
v_bitop3_b32 v66, v66, v195, s85 bitop3:0xf6
v_bitop3_b32 v66, v66, v197, s85 bitop3:0xf6
v_bitop3_b32 v66, v66, v199, s85 bitop3:0xf6
v_bitop3_b32 v66, v66, v201, s85 bitop3:0xf6
v_bitop3_b32 v66, v66, v203, s85 bitop3:0xf6
v_bitop3_b32 v66, v66, v205, s85 bitop3:0xf6
v_bitop3_b32 v66, v66, v207, s85 bitop3:0xf6
v_bitop3_b32 v66, v66, v209, s85 bitop3:0xf6
v_bitop3_b32 v66, v66, v211, s85 bitop3:0xf6
v_bitop3_b32 v66, v66, v213, s85 bitop3:0xf6
v_bitop3_b32 v66, v66, v215, s85 bitop3:0xf6
v_cmp_ne_u32 vcc, 0, v66
s_nop 4
s_sub_u32 s94, s94, 1
s_cmp_eq_u32 s94, 0
s_cbranch_scc1 L_p1_ln1_ok
s_cbranch_vccnz L_p1_ln1_spin
s_branch L_p1_ln1_ok
.section .rodata,"a"
.p2align 6
.amdhsa_kernel parallel_sum__ssm_conv_s5__glu_gated_geglu__prompt_kernel
  .amdhsa_next_free_vgpr 512
  .amdhsa_next_free_sgpr 102
  .amdhsa_accum_offset 256
  .amdhsa_group_segment_fixed_size 0
  .amdhsa_kernarg_size 128
  .amdhsa_user_sgpr_count 2
  .amdhsa_user_sgpr_kernarg_segment_ptr 1
  .amdhsa_system_sgpr_workgroup_id_x 1
.end_amdhsa_kernel
.text
```
